```python
import torch

def _softmax(x, axis=-1):
    return torch.softmax(x, dim=axis)
def _gelu(x):
    return torch.nn.functional.gelu(x, approximate="tanh")
def _silu(x):
    return torch.nn.functional.silu(x)
def _sigmoid(x):
    return torch.sigmoid(x)
def _layernorm(x, axis=-1, eps=1e-5):
    m = x.mean(dim=axis, keepdim=True)
    v = x.var(dim=axis, keepdim=True, unbiased=False)
    return (x - m) / torch.sqrt(v + eps)
def _scatter_add(tgt, idx, src, axis=0):
    return tgt.clone().index_add_(axis, idx, src)
def _segment_sum(src, seg, n):
    out = torch.zeros((n,) + src.shape[1:], dtype=src.dtype)
    return out.index_add_(0, seg, src)
def _pad(x, pw):
    flat = tuple(v for pair in reversed(pw) for v in pair)
    return torch.nn.functional.pad(x, flat)

kernel_name = 'parallel_sum__softmax_full_mha__mixer_channel_mlp__prompt'

def setup_inputs():

    _w = (lambda a: (lambda t: t.to(torch.bfloat16) if t.is_floating_point() else t)(torch.as_tensor(a)))
    def _A_setup():
        B, S, D = 1, 2048, 640
        return {
            "x": _w((lambda *s: torch.randn(*s, dtype=torch.bfloat16) * 0.05)(B, S, D)),
            "wqkv": _w((lambda *s: torch.randn(*s, dtype=torch.bfloat16) * 0.05)(D, 3 * D)),
            "wo": _w((lambda *s: torch.randn(*s, dtype=torch.bfloat16) * 0.05)(D, D)),
        }
    _A_in = _A_setup()

    def _B_setup():
        B, S, D, F = 1, 2048, 640, 1536
        return {
            "x": _w((lambda *s: torch.randn(*s, dtype=torch.bfloat16) * 0.05)(B, S, D)),
            "w1": _w((lambda *s: torch.randn(*s, dtype=torch.bfloat16) * 3.2)(D, F) * (D ** -0.5)),
            "b1": _w((lambda *s: torch.randn(*s, dtype=torch.bfloat16) * 1.6)(F)),
            "w2": _w((lambda *s: torch.randn(*s, dtype=torch.bfloat16) * 0.1)(F, D) * (F ** -0.5)),
            "b2": _w((lambda *s: torch.randn(*s, dtype=torch.bfloat16) * 0.2)(D)),
        }
    _B_in = _B_setup()

    return {
        "A_x": _A_in["x"],
        "A_wqkv": _A_in["wqkv"],
        "A_wo": _A_in["wo"],
        "B_x": _B_in["x"],
        "B_w1": _B_in["w1"],
        "B_b1": _B_in["b1"],
        "B_w2": _B_in["w2"],
        "B_b2": _B_in["b2"],
    }

def reference(A_x, A_wqkv, A_wo, B_x, B_w1, B_b1, B_w2, B_b2):
    def _A_ref(x, wqkv, wo):
        B, S, D = x.shape
        H = 32; Dh = D // H
        qkv = (lambda x, *d: x.permute(*d))((x @ wqkv).reshape(B, S, 3, H, Dh), 2, 0, 3, 1, 4)
        q, k, v = qkv[0], qkv[1], qkv[2]
        scale = Dh ** -0.5
        scores = torch.einsum("bhqd,bhkd->bhqk", q, k) * scale
        p = _softmax(scores, axis=-1)
        o = torch.einsum("bhqk,bhkd->bhqd", p, v)
        return (lambda x, *d: x.permute(*d))(o, 0, 2, 1, 3).reshape(B, S, D) @ wo

    def _B_ref(x, w1, b1, w2, b2):
        y = _layernorm(x, axis=-1)
        h = _gelu(torch.einsum("bsd,df->bsf", y, w1) + b1)
        return torch.einsum("bsf,fd->bsd", h, w2) + b2

    x = A_x
    xn = _layernorm(x, axis=-1)
    return x + _A_ref(xn, A_wqkv, A_wo) + _B_ref(xn, B_w1, B_b1, B_w2, B_b2)
```

```asm
; @launch grid=(256,1,1) block=(512,1,1) lds=158400
.amdgcn_target "amdgcn-amd-amdhsa--gfx950"
.text
.globl parallel_sum__softmax_full_mha__mixer_channel_mlp__prompt_kernel
.p2align 8
.type parallel_sum__softmax_full_mha__mixer_channel_mlp__prompt_kernel,@function
parallel_sum__softmax_full_mha__mixer_channel_mlp__prompt_kernel:
    s_cmp_ge_u32 s2, 256
    s_cbranch_scc1 parallel_sum__softmax_full_mha__mixer_channel_mlp__prompt_kernel_done
    s_load_dwordx16 s[24:39], s[0:1], 0
    s_load_dwordx4 s[40:43], s[0:1], 64
    s_load_dwordx2 s[44:45], s[0:1], 80
    s_getpc_b64 s[60:61]
    v_lshlrev_b32 v4, 6, v0
    s_and_b32 s60, s60, 0xffffff00
    v_mov_b32 v5, s61
    v_add_co_u32 v4, vcc, s60, v4
    s_movk_i32 s64, 401
    v_cmp_gt_u32 s[62:63], s64, v0
    v_addc_co_u32 v5, vcc, 0, v5, vcc
    s_mov_b64 exec, s[62:63]
    global_load_dword v191, v[4:5], off
    s_mov_b64 exec, -1
    v_lshrrev_b32 v2, 6, v0
    v_and_b32 v1, 63, v0
    s_and_b32 s56, s2, 7
    v_readfirstlane_b32 s3, v2
    s_lshr_b32 s57, s2, 3
    s_and_b32 s58, s57, 7
    s_lshr_b32 s59, s57, 3
    s_and_b32 s60, s56, 1
    s_lshl_b32 s60, s60, 3
    s_add_u32 s46, s60, s58
    s_lshr_b32 s60, s56, 1
    s_lshl_b32 s60, s60, 2
    s_add_u32 s47, s60, s59
    s_lshl_b32 s60, s56, 2
    s_add_u32 s48, s60, s59
    s_mov_b32 s49, s58
    s_and_b32 s60, s56, 3
    s_lshl_b32 s60, s60, 3
    s_add_u32 s50, s60, s58
    s_lshr_b32 s60, s56, 2
    s_lshl_b32 s60, s60, 2
    s_add_u32 s51, s60, s59
    v_and_b32 v2, 31, v1
    v_lshrrev_b32 v3, 5, v1
    s_cmp_ge_u32 s3, 4
    s_cbranch_scc0 parallel_sum__softmax_full_mha__mixer_channel_mlp__prompt_kernel_A
    s_setprio 3
    s_sub_u32 s52, s3, 4
    v_lshrrev_b32 v4, 3, v1
    v_mul_u32_u24 v4, 1280, v4
    v_and_b32 v5, 7, v1
    v_lshl_add_u32 v16, v5, 4, v4
    v_lshrrev_b32 v6, 4, v1
    v_xor_b32 v7, v5, v6
    v_xor_b32 v8, 4, v7
    v_lshl_add_u32 v74, v7, 4, v4
    v_lshl_add_u32 v75, v8, 4, v4
    v_add_u32 v75, 9216, v75
    v_lshl_add_u32 v76, v7, 4, v4
    v_add_u32 v76, 18432, v76
    v_lshl_add_u32 v77, v8, 4, v4
    v_add_u32 v77, 27648, v77
    v_mul_u32_u24 v4, 3840, v6
    v_and_b32 v5, 15, v1
    v_lshlrev_b32 v7, 2, v6
    v_xor_b32 v5, v5, v7
    v_lshl_add_u32 v78, v5, 4, v4
    v_add_u32 v79, 14336, v78
    v_add_u32 v80, 28672, v78
    v_add_u32 v81, 43008, v78
    v_add_u32 v4, 0, v1
    v_mul_u32_u24 v5, 43691, v4
    v_lshrrev_b32 v5, 19, v5
    v_mul_u32_u24 v6, 12, v5
    v_sub_u32 v6, v4, v6
    v_mov_b32 v26, v5
    v_lshlrev_b32 v29, 4, v6
    v_mul_u32_u24 v5, 3072, v5
    v_lshl_add_u32 v82, v6, 4, v5
    v_add_u32 v4, 64, v1
    v_mul_u32_u24 v5, 43691, v4
    v_lshrrev_b32 v5, 19, v5
    v_mul_u32_u24 v6, 12, v5
    v_sub_u32 v6, v4, v6
    v_mov_b32 v27, v5
    v_lshlrev_b32 v30, 4, v6
    v_mul_u32_u24 v5, 3072, v5
    v_lshl_add_u32 v83, v6, 4, v5
    v_subrev_u32 v83, 1024, v83
    v_add_u32 v4, 128, v1
    v_mul_u32_u24 v5, 43691, v4
    v_lshrrev_b32 v5, 19, v5
    v_mul_u32_u24 v6, 12, v5
    v_sub_u32 v6, v4, v6
    v_mov_b32 v28, v5
    v_lshlrev_b32 v31, 4, v6
    v_mul_u32_u24 v5, 3072, v5
    v_lshl_add_u32 v84, v6, 4, v5
    v_subrev_u32 v84, 2048, v84
    s_lshl_b32 s60, s46, 2
    s_add_u32 s60, s60, s52
    s_mul_i32 s53, s60, 40960
    s_mul_i32 s54, s52, 61440
    s_mul_i32 s60, s47, 240
    s_add_u32 s54, s54, s60
    s_mul_i32 s55, s52, 49152
    s_mul_i32 s60, s47, 192
    s_add_u32 s55, s55, s60
    s_lshl_b32 s56, s52, 12
    s_mul_i32 s57, s52, 3072
    s_add_u32 s57, s57, 98304
    s_mov_b32 s58, 0
    s_mov_b32 s59, 0
    v_mov_b32 v20, 0
    v_lshlrev_b32 v21, 4, v1
    v_lshlrev_b32 v22, 2, v1
    s_waitcnt lgkmcnt(0)
    s_mov_b32 s8, s24
    s_and_b32 s9, s25, 0xffff
    s_mov_b32 s10, 2621440
    s_mov_b32 s11, 0x00020000
    s_mov_b32 s12, s26
    s_and_b32 s13, s27, 0xffff
    s_mov_b32 s14, 2457600
    s_mov_b32 s15, 0x00020000
    s_mov_b32 s16, s32
    s_and_b32 s17, s33, 0xffff
    s_mov_b32 s18, 1966080
    s_mov_b32 s19, 0x00020000
    s_add_u32 m0, s56, s58
    s_nop 0
    buffer_load_dwordx4 v74, s[8:11], s53 offen offset:0 lds
    buffer_load_dwordx4 v75, s[8:11], s53 offen offset:1024 lds
    buffer_load_dwordx4 v76, s[8:11], s53 offen offset:2048 lds
    buffer_load_dwordx4 v77, s[8:11], s53 offen offset:3072 lds
    s_add_u32 m0, m0, 49152
    s_add_u32 s53, s53, 128
    buffer_load_dwordx4 v78, s[12:15], s54 offen offset:0 lds
    buffer_load_dwordx4 v79, s[12:15], s54 offen offset:1024 lds
    buffer_load_dwordx4 v80, s[12:15], s54 offen offset:2048 lds
    buffer_load_dwordx4 v81, s[12:15], s54 offen offset:3072 lds
    s_add_u32 m0, s57, s59
    s_add_u32 s54, s54, 245760
    buffer_load_dwordx4 v82, s[16:19], s55 offen offset:0 lds
    buffer_load_dwordx4 v83, s[16:19], s55 offen offset:1024 lds
    buffer_load_dwordx4 v84, s[16:19], s55 offen offset:2048 lds
    s_add_u32 s55, s55, 196608
    s_add_u32 s58, s58, 16384
    s_add_u32 s59, s59, 12288
    s_cmp_eq_u32 s58, 49152
    s_cselect_b32 s58, 0, s58
    s_cselect_b32 s59, 0, s59
    s_mov_b32 s4, s44
    s_and_b32 s5, s45, 0xffff
    s_mov_b32 s6, 268435456
    s_mov_b32 s7, 0x00020000
    s_mov_b32 s20, s42
    s_and_b32 s21, s43, 0xffff
    s_mov_b32 s22, 256
    s_mov_b32 s23, 0x00020000
    s_lshl_b32 s60, s2, 2
    s_add_u32 s60, s60, s52
    s_cmp_lg_u32 s60, 3
    s_cbranch_scc1 parallel_sum__softmax_full_mha__mixer_channel_mlp__prompt_kernel_nononce
    s_memrealtime s[60:61]
    s_waitcnt lgkmcnt(0)
    s_or_b32 s60, s60, 1
    v_mov_b32 v18, s60
    v_mov_b32 v19, s61
    s_mov_b64 exec, 1
    buffer_store_dwordx2 v[18:19], v20, s[20:23], 0 offen sc1
    s_mov_b64 exec, -1
parallel_sum__softmax_full_mha__mixer_channel_mlp__prompt_kernel_nononce:
    s_add_u32 m0, s56, s58
    s_nop 0
    buffer_load_dwordx4 v74, s[8:11], s53 offen offset:0 lds
    buffer_load_dwordx4 v75, s[8:11], s53 offen offset:1024 lds
    buffer_load_dwordx4 v76, s[8:11], s53 offen offset:2048 lds
    buffer_load_dwordx4 v77, s[8:11], s53 offen offset:3072 lds
    s_add_u32 m0, m0, 49152
    s_add_u32 s53, s53, 128
    buffer_load_dwordx4 v78, s[12:15], s54 offen offset:0 lds
    buffer_load_dwordx4 v79, s[12:15], s54 offen offset:1024 lds
    buffer_load_dwordx4 v80, s[12:15], s54 offen offset:2048 lds
    buffer_load_dwordx4 v81, s[12:15], s54 offen offset:3072 lds
    s_add_u32 m0, s57, s59
    s_add_u32 s54, s54, 245760
    buffer_load_dwordx4 v82, s[16:19], s55 offen offset:0 lds
    buffer_load_dwordx4 v83, s[16:19], s55 offen offset:1024 lds
    buffer_load_dwordx4 v84, s[16:19], s55 offen offset:2048 lds
    s_add_u32 s55, s55, 196608
    s_add_u32 s58, s58, 16384
    s_add_u32 s59, s59, 12288
    s_cmp_eq_u32 s58, 49152
    s_cselect_b32 s58, 0, s58
    s_cselect_b32 s59, 0, s59
    v_add_u32 v4, -256, v0
    v_mul_u32_u24 v5, 52429, v4
    v_lshrrev_b32 v5, 20, v5
    v_mul_u32_u24 v6, 20, v5
    v_sub_u32 v6, v4, v6
    v_mul_u32_u24 v7, 336, v5
    v_lshl_add_u32 v38, v6, 4, v7
    v_mul_u32_u24 v7, 1280, v5
    v_lshl_add_u32 v43, v6, 3, v7
    v_lshlrev_b32 v48, 3, v6
    v_add_u32 v4, 0, v0
    v_mul_u32_u24 v5, 52429, v4
    v_lshrrev_b32 v5, 20, v5
    v_mul_u32_u24 v6, 20, v5
    v_sub_u32 v6, v4, v6
    v_mul_u32_u24 v7, 336, v5
    v_lshl_add_u32 v39, v6, 4, v7
    v_mul_u32_u24 v7, 1280, v5
    v_lshl_add_u32 v44, v6, 3, v7
    v_lshlrev_b32 v49, 3, v6
    v_add_u32 v4, 256, v0
    v_mul_u32_u24 v5, 52429, v4
    v_lshrrev_b32 v5, 20, v5
    v_mul_u32_u24 v6, 20, v5
    v_sub_u32 v6, v4, v6
    v_mul_u32_u24 v7, 336, v5
    v_lshl_add_u32 v40, v6, 4, v7
    v_mul_u32_u24 v7, 1280, v5
    v_lshl_add_u32 v45, v6, 3, v7
    v_lshlrev_b32 v50, 3, v6
    v_add_u32 v4, 512, v0
    v_mul_u32_u24 v5, 52429, v4
    v_lshrrev_b32 v5, 20, v5
    v_mul_u32_u24 v6, 20, v5
    v_sub_u32 v6, v4, v6
    v_mul_u32_u24 v7, 336, v5
    v_lshl_add_u32 v41, v6, 4, v7
    v_mul_u32_u24 v7, 1280, v5
    v_lshl_add_u32 v46, v6, 3, v7
    v_lshlrev_b32 v51, 3, v6
    v_add_u32 v4, 768, v0
    v_mul_u32_u24 v5, 52429, v4
    v_lshrrev_b32 v5, 20, v5
    v_mul_u32_u24 v6, 20, v5
    v_sub_u32 v6, v4, v6
    v_mul_u32_u24 v7, 336, v5
    v_lshl_add_u32 v42, v6, 4, v7
    v_mul_u32_u24 v7, 1280, v5
    v_lshl_add_u32 v47, v6, 3, v7
    v_lshlrev_b32 v52, 3, v6
    s_waitcnt vmcnt(11)
    s_barrier
    s_add_u32 m0, s56, s58
    s_nop 0
    buffer_load_dwordx4 v74, s[8:11], s53 offen offset:0 lds
    buffer_load_dwordx4 v75, s[8:11], s53 offen offset:1024 lds
    buffer_load_dwordx4 v76, s[8:11], s53 offen offset:2048 lds
    buffer_load_dwordx4 v77, s[8:11], s53 offen offset:3072 lds
    s_add_u32 m0, m0, 49152
    s_add_u32 s53, s53, 128
    buffer_load_dwordx4 v78, s[12:15], s54 offen offset:0 lds
    buffer_load_dwordx4 v79, s[12:15], s54 offen offset:1024 lds
    buffer_load_dwordx4 v80, s[12:15], s54 offen offset:2048 lds
    buffer_load_dwordx4 v81, s[12:15], s54 offen offset:3072 lds
    s_add_u32 m0, s57, s59
    s_add_u32 s54, s54, 245760
    buffer_load_dwordx4 v82, s[16:19], s55 offen offset:0 lds
    buffer_load_dwordx4 v83, s[16:19], s55 offen offset:1024 lds
    buffer_load_dwordx4 v84, s[16:19], s55 offen offset:2048 lds
    s_add_u32 s55, s55, 196608
    s_add_u32 s58, s58, 16384
    s_add_u32 s59, s59, 12288
    s_cmp_eq_u32 s58, 49152
    s_cselect_b32 s58, 0, s58
    s_cselect_b32 s59, 0, s59
    s_lshl_b32 s62, s52, 8
    s_add_u32 s62, s62, s2
    s_mul_i32 s69, s52, 3072
    s_mul_hi_u32 s60, s62, 31580642
    s_mul_i32 s61, s60, 136
    s_sub_u32 s61, s62, s61
    s_mul_i32 s60, s60, 160
    s_cmp_ge_u32 s61, 96
    s_cbranch_scc1 rtw_1
    s_mov_b32 s64, s36
    s_and_b32 s65, s37, 0xffff
    s_mov_b32 s66, 1966080
    s_mov_b32 s67, 0x00020000
    s_mul_i32 s61, s61, 20480
    v_mov_b32 v4, v26
    v_mov_b32 v5, v27
    v_mov_b32 v6, v28
    s_branch rtg_3
rtw_1:
    s_mov_b32 s64, s28
    s_and_b32 s65, s29, 0xffff
    s_mov_b32 s66, 819200
    s_mov_b32 s67, 0x00020000
    s_cmp_ge_u32 s61, 128
    s_cbranch_scc1 rtt_2
    s_sub_u32 s61, s61, 96
    s_mul_i32 s61, s61, 25600
    v_mov_b32 v4, v26
    v_mov_b32 v5, v27
    v_mov_b32 v6, v28
    s_branch rtg_3
rtt_2:
    s_sub_u32 s61, s61, 128
    s_mul_i32 s61, s61, 102400
    v_bfe_u32 v7, v26, 2, 1
    v_bfe_u32 v8, v26, 3, 1
    v_lshl_add_u32 v7, v7, 1, v8
    v_mul_u32_u24 v7, 20, v7
    v_and_b32 v8, 3, v26
    v_add3_u32 v4, v7, v8, 16
    v_bfe_u32 v7, v27, 2, 1
    v_bfe_u32 v8, v27, 3, 1
    v_lshl_add_u32 v7, v7, 1, v8
    v_mul_u32_u24 v7, 20, v7
    v_and_b32 v8, 3, v27
    v_add3_u32 v5, v7, v8, 16
    v_bfe_u32 v7, v28, 2, 1
    v_bfe_u32 v8, v28, 3, 1
    v_lshl_add_u32 v7, v7, 1, v8
    v_mul_u32_u24 v7, 20, v7
    v_and_b32 v8, 3, v28
    v_add3_u32 v6, v7, v8, 16
rtg_3:
    s_add_u32 s61, s61, s60
    s_add_u32 m0, s69, 138816
    v_mul_u32_u24 v4, 1280, v4
    v_add_u32 v4, v4, v29
    v_mul_u32_u24 v5, 1280, v5
    v_add_u32 v5, v5, v30
    v_mul_u32_u24 v6, 1280, v6
    v_add_u32 v6, v6, v31
    buffer_load_dwordx4 v4, s[64:67], s61 offen lds
    s_add_u32 m0, m0, 1024
    s_nop 0
    buffer_load_dwordx4 v5, s[64:67], s61 offen lds
    s_add_u32 m0, m0, 1024
    s_nop 0
    buffer_load_dwordx4 v6, s[64:67], s61 offen lds
    s_add_u32 s63, s62, 1024
    s_cmp_ge_u32 s62, 64
    s_cbranch_scc1 parallel_sum__softmax_full_mha__mixer_channel_mlp__prompt_kernel_no2
    s_mul_hi_u32 s60, s63, 31580642
    s_mul_i32 s61, s60, 136
    s_sub_u32 s61, s63, s61
    s_mul_i32 s60, s60, 160
    s_cmp_ge_u32 s61, 96
    s_cbranch_scc1 rtw_4
    s_mov_b32 s64, s36
    s_and_b32 s65, s37, 0xffff
    s_mov_b32 s66, 1966080
    s_mov_b32 s67, 0x00020000
    s_mul_i32 s61, s61, 20480
    v_mov_b32 v4, v26
    v_mov_b32 v5, v27
    v_mov_b32 v6, v28
    s_branch rtg_6
rtw_4:
    s_mov_b32 s64, s28
    s_and_b32 s65, s29, 0xffff
    s_mov_b32 s66, 819200
    s_mov_b32 s67, 0x00020000
    s_cmp_ge_u32 s61, 128
    s_cbranch_scc1 rtt_5
    s_sub_u32 s61, s61, 96
    s_mul_i32 s61, s61, 25600
    v_mov_b32 v4, v26
    v_mov_b32 v5, v27
    v_mov_b32 v6, v28
    s_branch rtg_6
rtt_5:
    s_sub_u32 s61, s61, 128
    s_mul_i32 s61, s61, 102400
    v_bfe_u32 v7, v26, 2, 1
    v_bfe_u32 v8, v26, 3, 1
    v_lshl_add_u32 v7, v7, 1, v8
    v_mul_u32_u24 v7, 20, v7
    v_and_b32 v8, 3, v26
    v_add3_u32 v4, v7, v8, 16
    v_bfe_u32 v7, v27, 2, 1
    v_bfe_u32 v8, v27, 3, 1
    v_lshl_add_u32 v7, v7, 1, v8
    v_mul_u32_u24 v7, 20, v7
    v_and_b32 v8, 3, v27
    v_add3_u32 v5, v7, v8, 16
    v_bfe_u32 v7, v28, 2, 1
    v_bfe_u32 v8, v28, 3, 1
    v_lshl_add_u32 v7, v7, 1, v8
    v_mul_u32_u24 v7, 20, v7
    v_and_b32 v8, 3, v28
    v_add3_u32 v6, v7, v8, 16
rtg_6:
    s_add_u32 s61, s61, s60
    s_mov_b32 m0, 151104
    v_mul_u32_u24 v4, 1280, v4
    v_add_u32 v4, v4, v29
    v_mul_u32_u24 v5, 1280, v5
    v_add_u32 v5, v5, v30
    v_mul_u32_u24 v6, 1280, v6
    v_add_u32 v6, v6, v31
    buffer_load_dwordx4 v4, s[64:67], s61 offen lds
    s_add_u32 m0, m0, 1024
    s_nop 0
    buffer_load_dwordx4 v5, s[64:67], s61 offen lds
    s_add_u32 m0, m0, 1024
    s_nop 0
    buffer_load_dwordx4 v6, s[64:67], s61 offen lds
parallel_sum__softmax_full_mha__mixer_channel_mlp__prompt_kernel_no2:
    buffer_load_dwordx2 v[18:19], v20, s[20:23], 0 offen sc1
    s_mov_b32 s64, s38
    s_and_b32 s65, s39, 0xffff
    s_mov_b32 s66, 1280
    s_mov_b32 s67, 0x00020000
    s_mul_i32 s60, s50, 81920
    s_mul_i32 s61, s51, 160
    s_add_u32 s60, s60, s61
    buffer_load_dwordx2 v[164:165], v43, s[8:11], s60 offen
    buffer_load_dwordx2 v[166:167], v48, s[64:67], s61 offen
    buffer_load_dwordx2 v[168:169], v44, s[8:11], s60 offen
    buffer_load_dwordx2 v[170:171], v49, s[64:67], s61 offen
    buffer_load_dwordx2 v[172:173], v45, s[8:11], s60 offen
    buffer_load_dwordx2 v[174:175], v50, s[64:67], s61 offen
    buffer_load_dwordx2 v[176:177], v46, s[8:11], s60 offen
    buffer_load_dwordx2 v[178:179], v51, s[64:67], s61 offen
    buffer_load_dwordx2 v[180:181], v47, s[8:11], s60 offen
    buffer_load_dwordx2 v[182:183], v52, s[64:67], s61 offen
    v_lshlrev_b32 v12, 3, v1
    s_waitcnt vmcnt(25)
    s_barrier
    s_add_u32 m0, s56, s58
    s_nop 0
    buffer_load_dwordx4 v74, s[8:11], s53 offen offset:0 lds
    buffer_load_dwordx4 v75, s[8:11], s53 offen offset:1024 lds
    buffer_load_dwordx4 v76, s[8:11], s53 offen offset:2048 lds
    buffer_load_dwordx4 v77, s[8:11], s53 offen offset:3072 lds
    s_add_u32 m0, m0, 49152
    s_add_u32 s53, s53, 128
    buffer_load_dwordx4 v78, s[12:15], s54 offen offset:0 lds
    buffer_load_dwordx4 v79, s[12:15], s54 offen offset:1024 lds
    buffer_load_dwordx4 v80, s[12:15], s54 offen offset:2048 lds
    buffer_load_dwordx4 v81, s[12:15], s54 offen offset:3072 lds
    s_add_u32 m0, s57, s59
    s_add_u32 s54, s54, 245760
    buffer_load_dwordx4 v82, s[16:19], s55 offen offset:0 lds
    buffer_load_dwordx4 v83, s[16:19], s55 offen offset:1024 lds
    buffer_load_dwordx4 v84, s[16:19], s55 offen offset:2048 lds
    s_add_u32 s55, s55, 196608
    s_add_u32 s58, s58, 16384
    s_add_u32 s59, s59, 12288
    s_cmp_eq_u32 s58, 49152
    s_cselect_b32 s58, 0, s58
    s_cselect_b32 s59, 0, s59
    s_cmp_eq_u32 s52, 3
    s_cbranch_scc1 r3_8
    s_cmp_lg_u32 s52, 0
    s_cbranch_scc1 r12_7
    v_and_b32 v4, 7, v1
    v_lshlrev_b32 v4, 4, v4
    v_add_u32 v5, 154176, v4
    ds_read_b128 v[88:91], v5
    s_lshl_b32 s60, s46, 4
    s_add_u32 s60, s60, s47
    s_lshl_b32 s62, s60, 3
    s_add_u32 s62, s62, 24150016
    s_lshl_b32 s60, s60, 7
    s_add_u32 s60, s60, 24182784
    s_waitcnt lgkmcnt(0)
    buffer_store_dwordx4 v[88:91], v4, s[4:7], s60 offen sc1
    s_branch re_9
r12_7:
    s_lshl_b32 s61, s52, 11
    s_add_u32 s60, s61, 152256
    v_add_u32 v5, s60, v12
    ds_read_b64 v[88:89], v5 offset:0
    ds_read_b64 v[90:91], v5 offset:512
    ds_read_b64 v[92:93], v5 offset:1024
    ds_read_b64 v[94:95], v5 offset:1536
    s_lshl_b32 s60, s47, 4
    s_add_u32 s60, s60, s46
    s_lshl_b32 s62, s60, 3
    s_add_u32 s62, s62, s61
    s_add_u32 s62, s62, 24152064
    s_lshl_b32 s60, s60, 10
    s_lshr_b32 s61, s61, 2
    s_add_u32 s60, s60, s61
    s_add_u32 s60, s60, 24247808
    s_waitcnt lgkmcnt(0)
    v_pk_add_f32 v[88:89], v[88:89], v[90:91]
    v_pk_add_f32 v[88:89], v[88:89], v[92:93]
    v_pk_add_f32 v[88:89], v[88:89], v[94:95]
    buffer_store_dwordx2 v[88:89], v12, s[4:7], s60 offen sc1
    s_branch re_9
r3_8:
re_9:
    s_waitcnt vmcnt(25)
    s_barrier
    s_add_u32 m0, s56, s58
    s_nop 0
    buffer_load_dwordx4 v74, s[8:11], s53 offen offset:0 lds
    buffer_load_dwordx4 v75, s[8:11], s53 offen offset:1024 lds
    buffer_load_dwordx4 v76, s[8:11], s53 offen offset:2048 lds
    buffer_load_dwordx4 v77, s[8:11], s53 offen offset:3072 lds
    s_add_u32 m0, m0, 49152
    s_add_u32 s53, s53, 128
    buffer_load_dwordx4 v78, s[12:15], s54 offen offset:0 lds
    buffer_load_dwordx4 v79, s[12:15], s54 offen offset:1024 lds
    buffer_load_dwordx4 v80, s[12:15], s54 offen offset:2048 lds
    buffer_load_dwordx4 v81, s[12:15], s54 offen offset:3072 lds
    s_add_u32 m0, s57, s59
    s_add_u32 s54, s54, 245760
    buffer_load_dwordx4 v82, s[16:19], s55 offen offset:0 lds
    buffer_load_dwordx4 v83, s[16:19], s55 offen offset:1024 lds
    buffer_load_dwordx4 v84, s[16:19], s55 offen offset:2048 lds
    s_add_u32 s55, s55, 196608
    s_add_u32 s58, s58, 16384
    s_add_u32 s59, s59, 12288
    s_cmp_eq_u32 s58, 49152
    s_cselect_b32 s58, 0, s58
    s_cselect_b32 s59, 0, s59
    v_accvgpr_write_b32 a0, 0
    v_accvgpr_write_b32 a1, 0
    v_accvgpr_write_b32 a2, 0
    v_accvgpr_write_b32 a3, 0
    v_accvgpr_write_b32 a4, 0
    v_accvgpr_write_b32 a5, 0
    v_accvgpr_write_b32 a6, 0
    v_accvgpr_write_b32 a7, 0
    v_accvgpr_write_b32 a8, 0
    v_accvgpr_write_b32 a9, 0
    v_accvgpr_write_b32 a10, 0
    v_accvgpr_write_b32 a11, 0
    v_accvgpr_write_b32 a12, 0
    v_accvgpr_write_b32 a13, 0
    v_accvgpr_write_b32 a14, 0
    v_accvgpr_write_b32 a15, 0
    v_accvgpr_write_b32 a16, 0
    v_accvgpr_write_b32 a17, 0
    v_accvgpr_write_b32 a18, 0
    v_accvgpr_write_b32 a19, 0
    v_accvgpr_write_b32 a20, 0
    v_accvgpr_write_b32 a21, 0
    v_accvgpr_write_b32 a22, 0
    v_accvgpr_write_b32 a23, 0
    v_accvgpr_write_b32 a24, 0
    v_accvgpr_write_b32 a25, 0
    v_accvgpr_write_b32 a26, 0
    v_accvgpr_write_b32 a27, 0
    v_accvgpr_write_b32 a28, 0
    v_accvgpr_write_b32 a29, 0
    v_accvgpr_write_b32 a30, 0
    v_accvgpr_write_b32 a31, 0
    v_accvgpr_write_b32 a32, 0
    v_accvgpr_write_b32 a33, 0
    v_accvgpr_write_b32 a34, 0
    v_accvgpr_write_b32 a35, 0
    v_accvgpr_write_b32 a36, 0
    v_accvgpr_write_b32 a37, 0
    v_accvgpr_write_b32 a38, 0
    v_accvgpr_write_b32 a39, 0
    v_accvgpr_write_b32 a40, 0
    v_accvgpr_write_b32 a41, 0
    v_accvgpr_write_b32 a42, 0
    v_accvgpr_write_b32 a43, 0
    v_accvgpr_write_b32 a44, 0
    v_accvgpr_write_b32 a45, 0
    v_accvgpr_write_b32 a46, 0
    v_accvgpr_write_b32 a47, 0
    v_accvgpr_write_b32 a48, 0
    v_accvgpr_write_b32 a49, 0
    v_accvgpr_write_b32 a50, 0
    v_accvgpr_write_b32 a51, 0
    v_accvgpr_write_b32 a52, 0
    v_accvgpr_write_b32 a53, 0
    v_accvgpr_write_b32 a54, 0
    v_accvgpr_write_b32 a55, 0
    v_accvgpr_write_b32 a56, 0
    v_accvgpr_write_b32 a57, 0
    v_accvgpr_write_b32 a58, 0
    v_accvgpr_write_b32 a59, 0
    v_accvgpr_write_b32 a60, 0
    v_accvgpr_write_b32 a61, 0
    v_accvgpr_write_b32 a62, 0
    v_accvgpr_write_b32 a63, 0
    s_waitcnt vmcnt(11)
    s_barrier
    s_mov_b32 s68, 100000
parallel_sum__softmax_full_mha__mixer_channel_mlp__prompt_kernel_np_10:
    v_cmp_ne_u32 vcc, 0, v18
    s_cbranch_vccnz parallel_sum__softmax_full_mha__mixer_channel_mlp__prompt_kernel_ng_11
    s_sub_u32 s68, s68, 1
    s_cmp_eq_u32 s68, 0
    s_cbranch_scc1 parallel_sum__softmax_full_mha__mixer_channel_mlp__prompt_kernel_ng_11
    buffer_load_dwordx2 v[18:19], v20, s[20:23], 0 offen sc1
    s_waitcnt vmcnt(0)
    s_branch parallel_sum__softmax_full_mha__mixer_channel_mlp__prompt_kernel_np_10
parallel_sum__softmax_full_mha__mixer_channel_mlp__prompt_kernel_ng_11:
    s_cmp_eq_u32 s52, 3
    s_cbranch_scc1 r3_13
    s_cmp_lg_u32 s52, 0
    s_cbranch_scc1 r12_12
    s_mov_b64 exec, 1
    buffer_store_dwordx2 v[18:19], v20, s[4:7], s62 offen sc1
    s_mov_b64 exec, -1
    s_branch re_14
r12_12:
    s_mov_b64 exec, 1
    buffer_store_dwordx2 v[18:19], v20, s[4:7], s62 offen sc1
    s_mov_b64 exec, -1
    s_branch re_14
r3_13:
    v_mov_b32 v4, 138752
    ds_write_b64 v4, v[18:19]
re_14:
    s_add_u32 m0, s56, s58
    s_nop 0
    buffer_load_dwordx4 v74, s[8:11], s53 offen offset:0 lds
    buffer_load_dwordx4 v75, s[8:11], s53 offen offset:1024 lds
    buffer_load_dwordx4 v76, s[8:11], s53 offen offset:2048 lds
    buffer_load_dwordx4 v77, s[8:11], s53 offen offset:3072 lds
    s_add_u32 m0, m0, 49152
    s_add_u32 s53, s53, 128
    buffer_load_dwordx4 v78, s[12:15], s54 offen offset:0 lds
    buffer_load_dwordx4 v79, s[12:15], s54 offen offset:1024 lds
    buffer_load_dwordx4 v80, s[12:15], s54 offen offset:2048 lds
    buffer_load_dwordx4 v81, s[12:15], s54 offen offset:3072 lds
    s_add_u32 m0, s57, s59
    s_add_u32 s54, s54, 245760
    buffer_load_dwordx4 v82, s[16:19], s55 offen offset:0 lds
    buffer_load_dwordx4 v83, s[16:19], s55 offen offset:1024 lds
    buffer_load_dwordx4 v84, s[16:19], s55 offen offset:2048 lds
    s_add_u32 s55, s55, 196608
    s_add_u32 s58, s58, 16384
    s_add_u32 s59, s59, 12288
    s_cmp_eq_u32 s58, 49152
    s_cselect_b32 s58, 0, s58
    s_cselect_b32 s59, 0, s59
    v_lshlrev_b32 v13, 16, v164
    v_lshlrev_b32 v14, 16, v166
    v_add_f32 v54, v13, v14
    v_and_b32 v13, 0xffff0000, v164
    v_and_b32 v14, 0xffff0000, v166
    v_add_f32 v55, v13, v14
    v_lshlrev_b32 v13, 16, v165
    v_lshlrev_b32 v14, 16, v167
    v_add_f32 v56, v13, v14
    v_and_b32 v13, 0xffff0000, v165
    v_and_b32 v14, 0xffff0000, v167
    v_add_f32 v57, v13, v14
    v_lshlrev_b32 v13, 16, v168
    v_lshlrev_b32 v14, 16, v170
    v_add_f32 v58, v13, v14
    v_and_b32 v13, 0xffff0000, v168
    v_and_b32 v14, 0xffff0000, v170
    v_add_f32 v59, v13, v14
    v_lshlrev_b32 v13, 16, v169
    v_lshlrev_b32 v14, 16, v171
    v_add_f32 v60, v13, v14
    v_and_b32 v13, 0xffff0000, v169
    v_and_b32 v14, 0xffff0000, v171
    v_add_f32 v61, v13, v14
    v_lshlrev_b32 v13, 16, v172
    v_lshlrev_b32 v14, 16, v174
    v_add_f32 v62, v13, v14
    v_and_b32 v13, 0xffff0000, v172
    v_and_b32 v14, 0xffff0000, v174
    v_add_f32 v63, v13, v14
    v_lshlrev_b32 v13, 16, v173
    v_lshlrev_b32 v14, 16, v175
    v_add_f32 v64, v13, v14
    v_and_b32 v13, 0xffff0000, v173
    v_and_b32 v14, 0xffff0000, v175
    v_add_f32 v65, v13, v14
    v_lshlrev_b32 v13, 16, v176
    v_lshlrev_b32 v14, 16, v178
    v_add_f32 v66, v13, v14
    v_and_b32 v13, 0xffff0000, v176
    v_and_b32 v14, 0xffff0000, v178
    v_add_f32 v67, v13, v14
    v_lshlrev_b32 v13, 16, v177
    v_lshlrev_b32 v14, 16, v179
    v_add_f32 v68, v13, v14
    v_and_b32 v13, 0xffff0000, v177
    v_and_b32 v14, 0xffff0000, v179
    v_add_f32 v69, v13, v14
    v_lshlrev_b32 v13, 16, v180
    v_lshlrev_b32 v14, 16, v182
    v_add_f32 v70, v13, v14
    v_and_b32 v13, 0xffff0000, v180
    v_and_b32 v14, 0xffff0000, v182
    v_add_f32 v71, v13, v14
    v_lshlrev_b32 v13, 16, v181
    v_lshlrev_b32 v14, 16, v183
    v_add_f32 v72, v13, v14
    v_and_b32 v13, 0xffff0000, v181
    v_and_b32 v14, 0xffff0000, v183
    v_add_f32 v73, v13, v14
    v_and_b32 v4, 15, v1
    v_lshlrev_b32 v4, 3, v4
    s_mov_b32 s63, 4
parallel_sum__softmax_full_mha__mixer_channel_mlp__prompt_kernel_bl:
    s_waitcnt vmcnt(11)
    s_barrier
    s_add_u32 m0, s56, s58
    s_nop 0
    buffer_load_dwordx4 v74, s[8:11], s53 offen offset:0 lds
    buffer_load_dwordx4 v75, s[8:11], s53 offen offset:1024 lds
    buffer_load_dwordx4 v76, s[8:11], s53 offen offset:2048 lds
    buffer_load_dwordx4 v77, s[8:11], s53 offen offset:3072 lds
    s_add_u32 m0, m0, 49152
    s_add_u32 s53, s53, 128
    buffer_load_dwordx4 v78, s[12:15], s54 offen offset:0 lds
    buffer_load_dwordx4 v79, s[12:15], s54 offen offset:1024 lds
    buffer_load_dwordx4 v80, s[12:15], s54 offen offset:2048 lds
    buffer_load_dwordx4 v81, s[12:15], s54 offen offset:3072 lds
    s_add_u32 m0, s57, s59
    s_add_u32 s54, s54, 245760
    buffer_load_dwordx4 v82, s[16:19], s55 offen offset:0 lds
    buffer_load_dwordx4 v83, s[16:19], s55 offen offset:1024 lds
    buffer_load_dwordx4 v84, s[16:19], s55 offen offset:2048 lds
    s_add_u32 s55, s55, 196608
    s_add_u32 s58, s58, 16384
    s_add_u32 s59, s59, 12288
    s_cmp_eq_u32 s58, 49152
    s_cselect_b32 s58, 0, s58
    s_cselect_b32 s59, 0, s59
    s_add_u32 s63, s63, 1
    s_cmp_lt_u32 s63, 8
    s_cbranch_scc1 parallel_sum__softmax_full_mha__mixer_channel_mlp__prompt_kernel_bl
    s_waitcnt vmcnt(11)
    s_barrier
    s_cmp_eq_u32 s52, 3
    s_cbranch_scc1 r3_16
    s_cmp_lg_u32 s52, 0
    s_cbranch_scc1 r12_15
    s_lshl_b32 s60, s46, 7
    s_add_u32 s60, s60, 24150016
    s_mov_b32 s68, 100000
parallel_sum__softmax_full_mha__mixer_channel_mlp__prompt_kernel_sr_p_18:
    buffer_load_dwordx2 v[88:89], v4, s[4:7], s60 offen sc1
    s_sub_u32 s68, s68, 1
    s_cmp_eq_u32 s68, 0
    s_cbranch_scc1 parallel_sum__softmax_full_mha__mixer_channel_mlp__prompt_kernel_sr_g_19
    s_waitcnt vmcnt(0)
    v_cmp_ne_u64 vcc, v[18:19], v[88:89]
    s_cbranch_vccz parallel_sum__softmax_full_mha__mixer_channel_mlp__prompt_kernel_sr_g_19
    s_sleep 1
    s_branch parallel_sum__softmax_full_mha__mixer_channel_mlp__prompt_kernel_sr_p_18
parallel_sum__softmax_full_mha__mixer_channel_mlp__prompt_kernel_sr_g_19:
    s_lshl_b32 s60, s46, 11
    s_add_u32 s60, s60, 24182784
    s_waitcnt vmcnt(0)
    buffer_load_dwordx4 v[88:91], v21, s[4:7], s60 offen sc1
    buffer_load_dwordx4 v[92:95], v21, s[4:7], s60 offen offset:1024 sc1
    s_branch re_17
r12_15:
    s_lshl_b32 s61, s52, 11
    s_lshl_b32 s60, s47, 7
    s_add_u32 s60, s60, s61
    s_add_u32 s60, s60, 24152064
    s_mov_b32 s68, 100000
parallel_sum__softmax_full_mha__mixer_channel_mlp__prompt_kernel_sc_p_20:
    buffer_load_dwordx2 v[88:89], v4, s[4:7], s60 offen sc1
    s_sub_u32 s68, s68, 1
    s_cmp_eq_u32 s68, 0
    s_cbranch_scc1 parallel_sum__softmax_full_mha__mixer_channel_mlp__prompt_kernel_sc_g_21
    s_waitcnt vmcnt(0)
    v_cmp_ne_u64 vcc, v[18:19], v[88:89]
    s_cbranch_vccz parallel_sum__softmax_full_mha__mixer_channel_mlp__prompt_kernel_sc_g_21
    s_sleep 1
    s_branch parallel_sum__softmax_full_mha__mixer_channel_mlp__prompt_kernel_sc_p_20
parallel_sum__softmax_full_mha__mixer_channel_mlp__prompt_kernel_sc_g_21:
    s_lshl_b32 s60, s47, 14
    s_lshr_b32 s61, s61, 2
    s_add_u32 s60, s60, s61
    s_add_u32 s60, s60, 24247808
    s_waitcnt vmcnt(0)
    buffer_load_dwordx2 v[88:89], v12, s[4:7], s60 offen offset:0 sc1
    buffer_load_dwordx2 v[90:91], v12, s[4:7], s60 offen offset:1024 sc1
    buffer_load_dwordx2 v[92:93], v12, s[4:7], s60 offen offset:2048 sc1
    buffer_load_dwordx2 v[94:95], v12, s[4:7], s60 offen offset:3072 sc1
    s_add_u32 s60, s60, 4096
    buffer_load_dwordx2 v[96:97], v12, s[4:7], s60 offen offset:0 sc1
    buffer_load_dwordx2 v[98:99], v12, s[4:7], s60 offen offset:1024 sc1
    buffer_load_dwordx2 v[100:101], v12, s[4:7], s60 offen offset:2048 sc1
    buffer_load_dwordx2 v[102:103], v12, s[4:7], s60 offen offset:3072 sc1
    s_add_u32 s60, s60, 4096
    buffer_load_dwordx2 v[104:105], v12, s[4:7], s60 offen offset:0 sc1
    buffer_load_dwordx2 v[106:107], v12, s[4:7], s60 offen offset:1024 sc1
    buffer_load_dwordx2 v[108:109], v12, s[4:7], s60 offen offset:2048 sc1
    buffer_load_dwordx2 v[110:111], v12, s[4:7], s60 offen offset:3072 sc1
    s_add_u32 s60, s60, 4096
    buffer_load_dwordx2 v[112:113], v12, s[4:7], s60 offen offset:0 sc1
    buffer_load_dwordx2 v[114:115], v12, s[4:7], s60 offen offset:1024 sc1
    buffer_load_dwordx2 v[116:117], v12, s[4:7], s60 offen offset:2048 sc1
    buffer_load_dwordx2 v[118:119], v12, s[4:7], s60 offen offset:3072 sc1
    s_branch re_17
r3_16:
    s_waitcnt vmcnt(0)
re_17:
    s_barrier
    s_waitcnt vmcnt(0)
    s_cmp_eq_u32 s52, 3
    s_cbranch_scc1 r3_23
    s_cmp_lg_u32 s52, 0
    s_cbranch_scc1 r12_22
    v_add_u32 v4, 135168, v21
    ds_write_b128 v4, v[88:91]
    ds_write_b128 v4, v[92:95] offset:1024
    s_branch re_24
r12_22:
    s_lshl_b32 s61, s52, 9
    s_add_u32 s61, s61, 136704
    v_add_u32 v4, s61, v12
    v_pk_add_f32 v[88:89], v[88:89], v[90:91]
    v_pk_add_f32 v[88:89], v[88:89], v[92:93]
    v_pk_add_f32 v[88:89], v[88:89], v[94:95]
    v_pk_add_f32 v[88:89], v[88:89], v[96:97]
    v_pk_add_f32 v[88:89], v[88:89], v[98:99]
    v_pk_add_f32 v[88:89], v[88:89], v[100:101]
    v_pk_add_f32 v[88:89], v[88:89], v[102:103]
    v_pk_add_f32 v[88:89], v[88:89], v[104:105]
    v_pk_add_f32 v[88:89], v[88:89], v[106:107]
    v_pk_add_f32 v[88:89], v[88:89], v[108:109]
    v_pk_add_f32 v[88:89], v[88:89], v[110:111]
    v_pk_add_f32 v[88:89], v[88:89], v[112:113]
    v_pk_add_f32 v[88:89], v[88:89], v[114:115]
    v_pk_add_f32 v[88:89], v[88:89], v[116:117]
    v_pk_add_f32 v[88:89], v[88:89], v[118:119]
    ds_write_b64 v4, v[88:89]
    s_branch re_24
r3_23:
re_24:
    s_waitcnt lgkmcnt(0)
    s_barrier
    s_setprio 0
    s_mov_b32 s16, s40
    s_and_b32 s17, s41, 0xffff
    s_mov_b32 s18, 2621440
    s_mov_b32 s19, 0x00020000
    s_mul_i32 s58, s50, 81920
    s_mul_i32 s59, s51, 160
    s_add_u32 s58, s58, s59
    s_mul_i32 s60, s52, 25600
    v_add_u32 v8, s60, v21
    s_mul_i32 s61, s52, 25600
    v_mul_u32_u24 v10, 336, v2
    v_lshl_add_u32 v10, v3, 4, v10
    v_add_u32 v10, s61, v10
    v_and_b32 v11, 7, v1
    v_lshlrev_b32 v11, 3, v11
    v_mov_b32 v12, 138768
    v_add_u32 v23, 0x1000, v21
    v_and_b32 v24, 15, v1
    v_lshl_add_u32 v24, v3, 4, v24
    v_lshlrev_b32 v24, 4, v24
    s_mul_i32 s60, s52, 25600
    v_add_u32 v9, s60, v24
    v_bfe_u32 v25, v1, 4, 1
    v_lshl_add_u32 v24, v25, 30, v24
    v_mov_b32 v156, 0
    v_mov_b32 v157, 0
    v_mov_b32 v158, 0
    v_mov_b32 v159, 0
    v_mov_b32 v160, 0
    v_mov_b32 v161, 0
    v_mov_b32 v162, 0
    v_mov_b32 v163, 0
    v_mov_b32 v164, 0
    v_mov_b32 v165, 0
    v_mov_b32 v166, 0
    v_mov_b32 v167, 0
    v_mov_b32 v168, 0
    v_mov_b32 v169, 0
    v_mov_b32 v170, 0
    v_mov_b32 v171, 0
    v_mov_b32 v172, 0
    v_mov_b32 v173, 0
    v_mov_b32 v174, 0
    v_mov_b32 v175, 0
    v_mov_b32 v176, 0
    v_mov_b32 v177, 0
    v_mov_b32 v178, 0
    v_mov_b32 v179, 0
    v_mov_b32 v180, 0
    v_mov_b32 v181, 0
    v_mov_b32 v182, 0
    v_mov_b32 v183, 0
    v_mov_b32 v184, 0
    v_mov_b32 v185, 0
    v_mov_b32 v186, 0
    v_mov_b32 v187, 0
    s_mul_i32 s53, s50, 196608
    s_mul_i32 s60, s52, 24576
    s_add_u32 s53, s53, s60
    s_add_u32 s53, s53, 10485760
    s_add_u32 s54, s53, 98304
    s_mul_i32 s56, s51, 136
    s_mul_i32 s60, s52, 24
    s_add_u32 s60, s60, s56
    s_mul_i32 s55, s60, 2560
    s_add_u32 s55, s55, 19922944
    v_bfe_u32 v4, v1, 1, 2
    v_lshlrev_b32 v4, 5, v4
    v_and_b32 v5, 1, v1
    v_lshl_add_u32 v4, v5, 4, v4
    s_lshr_b32 s60, s50, 1
    s_lshl_b32 s60, s60, 9
    s_lshl_b32 s61, s52, 7
    s_add_u32 s60, s60, s61
    s_and_b32 s61, s50, 1
    s_lshl_b32 s61, s61, 3
    s_add_u32 s60, s60, s61
    s_add_u32 s63, s60, 24125440
    s_mul_i32 s60, s51, 1088
    s_add_u32 s64, s60, 24158208
    s_mul_i32 s60, s52, 24
    v_min_u32 v6, 23, v1
    v_add_u32 v6, s60, v6
    v_lshlrev_b32 v6, 3, v6
    s_lshl_b32 s60, s52, 3
    s_add_u32 s60, s60, 96
    v_and_b32 v7, 7, v1
    v_add_u32 v7, s60, v7
    s_lshl_b32 s60, s52, 1
    s_add_u32 s60, s60, 128
    v_and_b32 v5, 1, v1
    v_add_u32 v5, s60, v5
    v_cmp_eq_u32 vcc, 0, v3
    s_nop 1
    v_cndmask_b32 v7, v5, v7, vcc
    v_lshlrev_b32 v7, 3, v7
    s_and_b32 s60, s52, 1
    s_lshl_b32 s61, s46, 1
    s_add_u32 s60, s60, s61
    s_lshl_b32 s60, s60, 1
    s_mul_i32 s60, s60, 96
    s_mul_i32 s61, s47, 6
    s_add_u32 s60, s60, s61
    s_lshl_b32 s60, s60, 10
    s_add_u32 s60, s60, 10485760
    s_lshr_b32 s61, s52, 1
    s_mul_i32 s65, s61, 98304
    s_lshl_b32 s61, s61, 12
    s_add_u32 s66, s60, s65
    s_sub_u32 s67, s60, s65
    s_add_u32 s67, s67, 98304
    s_add_u32 s67, s67, s61
    s_add_u32 s65, s66, s61
    s_lshl_b32 s60, s46, 4
    s_add_u32 s60, s60, s47
    s_lshl_b32 s60, s60, 2
    s_add_u32 s60, s60, s52
    s_lshl_b32 s60, s60, 3
    s_add_u32 s57, s60, 24125440
    s_mul_i32 s60, s52, 10240
    s_add_u32 s60, s60, 49152
    v_add_u32 v13, s60, v21
    v_bfe_u32 v14, v1, 2, 2
    v_lshl_add_u32 v14, v3, 2, v14
    v_mul_u32_u24 v14, 192, v14
    v_bfe_u32 v15, v1, 4, 1
    v_lshl_add_u32 v14, v15, 5, v14
    v_and_b32 v15, 3, v1
    v_lshl_add_u32 v14, v15, 3, v14
    v_add_u32 v15, 151104, v14
    s_mul_i32 s60, s52, 3072
    s_add_u32 s60, s60, 138816
    v_add_u32 v14, s60, v14
    ds_read_b64_tr_b16 v[116:117], v14 offset:0
    ds_read_b64_tr_b16 v[118:119], v14 offset:1536
    ds_read_b64_tr_b16 v[120:121], v14 offset:64
    ds_read_b64_tr_b16 v[122:123], v14 offset:1600
    ds_read_b64_tr_b16 v[124:125], v14 offset:128
    ds_read_b64_tr_b16 v[126:127], v14 offset:1664
    ds_read_b64_tr_b16 v[128:129], v15 offset:0
    ds_read_b64_tr_b16 v[130:131], v15 offset:1536
    ds_read_b64_tr_b16 v[132:133], v15 offset:64
    ds_read_b64_tr_b16 v[134:135], v15 offset:1600
    ds_read_b64_tr_b16 v[136:137], v15 offset:128
    ds_read_b64_tr_b16 v[138:139], v15 offset:1664
    s_lshl_b32 s62, s52, 8
    s_add_u32 s62, s62, s2
    v_cmp_gt_u32 s[12:13], 16, v2
    s_barrier
    ds_read_b128 v[76:79], v13 offset:0
    ds_read_b128 v[80:83], v13 offset:1024
    ds_read_b128 v[84:87], v13 offset:2048
    ds_read_b128 v[88:91], v13 offset:3072
    ds_read_b128 v[92:95], v13 offset:4096
    ds_read_b128 v[96:99], v13 offset:5120
    s_waitcnt lgkmcnt(0)
    buffer_store_dwordx4 v[76:79], v21, s[4:7], s65 offen offset:0 sc1
    buffer_store_dwordx4 v[80:83], v21, s[4:7], s65 offen offset:1024 sc1
    buffer_store_dwordx4 v[84:87], v21, s[4:7], s67 offen offset:0 sc1
    buffer_store_dwordx4 v[88:91], v21, s[4:7], s67 offen offset:1024 sc1
    buffer_store_dwordx4 v[92:95], v21, s[4:7], s66 offen offset:2048 sc1
    buffer_store_dwordx4 v[96:99], v21, s[4:7], s66 offen offset:3072 sc1
    s_mul_i32 s61, s62, 2560
    s_add_u32 s61, s61, 19922944
    buffer_store_dwordx4 v[116:119], v21, s[4:7], s61 offen sc1
    buffer_store_dwordx4 v[120:123], v21, s[4:7], s61 offen offset:1024 sc1
    s_mov_b64 exec, s[12:13]
    buffer_store_dwordx4 v[124:127], v24, s[4:7], s61 offen offset:2048 sc1
    s_mov_b64 exec, -1
    s_lshl_b32 s61, s62, 3
    s_add_u32 s61, s61, 24158208
    s_waitcnt vmcnt(0)
    s_mov_b64 exec, 1
    buffer_store_dwordx2 v[18:19], v20, s[4:7], s61 offen sc1
    s_mov_b64 exec, -1
    s_mov_b64 exec, 1
    buffer_store_dwordx2 v[18:19], v20, s[4:7], s57 offen sc1
    s_mov_b64 exec, -1
    s_cmp_ge_u32 s62, 64
    s_cbranch_scc1 parallel_sum__softmax_full_mha__mixer_channel_mlp__prompt_kernel_no3
    s_add_u32 s62, s62, 1024
    s_mul_i32 s61, s62, 2560
    s_add_u32 s61, s61, 19922944
    buffer_store_dwordx4 v[128:131], v21, s[4:7], s61 offen sc1
    buffer_store_dwordx4 v[132:135], v21, s[4:7], s61 offen offset:1024 sc1
    s_mov_b64 exec, s[12:13]
    buffer_store_dwordx4 v[136:139], v24, s[4:7], s61 offen offset:2048 sc1
    s_mov_b64 exec, -1
    s_lshl_b32 s61, s62, 3
    s_add_u32 s61, s61, 24158208
    s_waitcnt vmcnt(0)
    s_mov_b64 exec, 1
    buffer_store_dwordx2 v[18:19], v20, s[4:7], s61 offen sc1
    s_mov_b64 exec, -1
parallel_sum__softmax_full_mha__mixer_channel_mlp__prompt_kernel_no3:
    s_mov_b32 s68, 100000
parallel_sum__softmax_full_mha__mixer_channel_mlp__prompt_kernel_fw_p_25:
    buffer_load_dwordx2 v[48:49], v6, s[4:7], s64 offen sc1
    buffer_load_dwordx2 v[50:51], v7, s[4:7], s64 offen sc1
    s_sub_u32 s68, s68, 1
    s_cmp_eq_u32 s68, 0
    s_cbranch_scc1 parallel_sum__softmax_full_mha__mixer_channel_mlp__prompt_kernel_fw_g_26
    s_waitcnt vmcnt(0)
    v_cmp_ne_u64 vcc, v[18:19], v[48:49]
    v_cmp_ne_u64 s[66:67], v[18:19], v[50:51]
    s_or_b64 vcc, vcc, s[66:67]
    s_cbranch_vccz parallel_sum__softmax_full_mha__mixer_channel_mlp__prompt_kernel_fw_g_26
    s_sleep 12
    s_branch parallel_sum__softmax_full_mha__mixer_channel_mlp__prompt_kernel_fw_p_25
parallel_sum__softmax_full_mha__mixer_channel_mlp__prompt_kernel_fw_g_26:
    s_mov_b32 s68, 100000
parallel_sum__softmax_full_mha__mixer_channel_mlp__prompt_kernel_fh_p_27:
    buffer_load_dwordx2 v[48:49], v4, s[4:7], s63 offen sc1
    s_sub_u32 s68, s68, 1
    s_cmp_eq_u32 s68, 0
    s_cbranch_scc1 parallel_sum__softmax_full_mha__mixer_channel_mlp__prompt_kernel_fh_g_28
    s_waitcnt vmcnt(0)
    v_cmp_ne_u64 vcc, v[18:19], v[48:49]
    s_cbranch_vccz parallel_sum__softmax_full_mha__mixer_channel_mlp__prompt_kernel_fh_g_28
    s_sleep 12
    s_branch parallel_sum__softmax_full_mha__mixer_channel_mlp__prompt_kernel_fh_p_27
parallel_sum__softmax_full_mha__mixer_channel_mlp__prompt_kernel_fh_g_28:
    s_setprio 0
    buffer_load_dwordx4 v[76:79], v21, s[4:7], s53 offen sc1
    buffer_load_dwordx4 v[80:83], v21, s[4:7], s54 offen sc1
    buffer_load_dwordx4 v[84:87], v21, s[4:7], s55 offen sc1
    buffer_load_dwordx4 v[88:91], v21, s[4:7], s55 offen offset:1024 sc1
    buffer_load_dwordx4 v[92:95], v24, s[4:7], s55 offen offset:2048 sc1
    s_add_u32 s53, s53, 1024
    s_add_u32 s54, s54, 1024
    s_add_u32 s55, s55, 2560
    buffer_load_dwordx4 v[96:99], v21, s[4:7], s53 offen sc1
    buffer_load_dwordx4 v[100:103], v21, s[4:7], s54 offen sc1
    buffer_load_dwordx4 v[104:107], v21, s[4:7], s55 offen sc1
    buffer_load_dwordx4 v[108:111], v21, s[4:7], s55 offen offset:1024 sc1
    buffer_load_dwordx4 v[112:115], v24, s[4:7], s55 offen offset:2048 sc1
    s_add_u32 s53, s53, 1024
    s_add_u32 s54, s54, 1024
    s_add_u32 s55, s55, 2560
    s_mov_b32 s60, 0
parallel_sum__softmax_full_mha__mixer_channel_mlp__prompt_kernel_gl_29:
    s_waitcnt vmcnt(5)
    v_mfma_f32_32x32x16_bf16 a[0:15], v[84:87], v[76:79], a[0:15]
    buffer_load_dwordx4 v[116:119], v21, s[4:7], s53 offen sc1
    v_mfma_f32_32x32x16_bf16 a[16:31], v[84:87], v[80:83], a[16:31]
    buffer_load_dwordx4 v[120:123], v21, s[4:7], s54 offen sc1
    v_mfma_f32_32x32x16_bf16 a[32:47], v[88:91], v[76:79], a[32:47]
    buffer_load_dwordx4 v[124:127], v21, s[4:7], s55 offen sc1
    v_mfma_f32_32x32x16_bf16 a[48:63], v[88:91], v[80:83], a[48:63]
    buffer_load_dwordx4 v[128:131], v21, s[4:7], s55 offen offset:1024 sc1
    v_mfma_f32_32x32x16_bf16 v[156:171], v[92:95], v[76:79], v[156:171]
    buffer_load_dwordx4 v[132:135], v24, s[4:7], s55 offen offset:2048 sc1
    v_mfma_f32_32x32x16_bf16 v[172:187], v[92:95], v[80:83], v[172:187]
    s_add_u32 s53, s53, 1024
    s_add_u32 s54, s54, 1024
    s_add_u32 s55, s55, 2560
    s_waitcnt vmcnt(5)
    v_mfma_f32_32x32x16_bf16 a[0:15], v[104:107], v[96:99], a[0:15]
    buffer_load_dwordx4 v[76:79], v21, s[4:7], s53 offen sc1
    v_mfma_f32_32x32x16_bf16 a[16:31], v[104:107], v[100:103], a[16:31]
    buffer_load_dwordx4 v[80:83], v21, s[4:7], s54 offen sc1
    v_mfma_f32_32x32x16_bf16 a[32:47], v[108:111], v[96:99], a[32:47]
    buffer_load_dwordx4 v[84:87], v21, s[4:7], s55 offen sc1
    v_mfma_f32_32x32x16_bf16 a[48:63], v[108:111], v[100:103], a[48:63]
    buffer_load_dwordx4 v[88:91], v21, s[4:7], s55 offen offset:1024 sc1
    v_mfma_f32_32x32x16_bf16 v[156:171], v[112:115], v[96:99], v[156:171]
    buffer_load_dwordx4 v[92:95], v24, s[4:7], s55 offen offset:2048 sc1
    v_mfma_f32_32x32x16_bf16 v[172:187], v[112:115], v[100:103], v[172:187]
    s_add_u32 s53, s53, 1024
    s_add_u32 s54, s54, 1024
    s_add_u32 s55, s55, 2560
    s_waitcnt vmcnt(5)
    v_mfma_f32_32x32x16_bf16 a[0:15], v[124:127], v[116:119], a[0:15]
    buffer_load_dwordx4 v[96:99], v21, s[4:7], s53 offen sc1
    v_mfma_f32_32x32x16_bf16 a[16:31], v[124:127], v[120:123], a[16:31]
    buffer_load_dwordx4 v[100:103], v21, s[4:7], s54 offen sc1
    v_mfma_f32_32x32x16_bf16 a[32:47], v[128:131], v[116:119], a[32:47]
    buffer_load_dwordx4 v[104:107], v21, s[4:7], s55 offen sc1
    v_mfma_f32_32x32x16_bf16 a[48:63], v[128:131], v[120:123], a[48:63]
    buffer_load_dwordx4 v[108:111], v21, s[4:7], s55 offen offset:1024 sc1
    v_mfma_f32_32x32x16_bf16 v[156:171], v[132:135], v[116:119], v[156:171]
    buffer_load_dwordx4 v[112:115], v24, s[4:7], s55 offen offset:2048 sc1
    v_mfma_f32_32x32x16_bf16 v[172:187], v[132:135], v[120:123], v[172:187]
    s_add_u32 s53, s53, 1024
    s_add_u32 s54, s54, 1024
    s_add_u32 s55, s55, 2560
    s_add_u32 s60, s60, 1
    s_cmp_lt_u32 s60, 5
    s_cbranch_scc1 parallel_sum__softmax_full_mha__mixer_channel_mlp__prompt_kernel_gl_29
    s_waitcnt vmcnt(5)
    v_mfma_f32_32x32x16_bf16 a[0:15], v[84:87], v[76:79], a[0:15]
    buffer_load_dwordx4 v[116:119], v21, s[4:7], s53 offen sc1
    v_mfma_f32_32x32x16_bf16 a[16:31], v[84:87], v[80:83], a[16:31]
    buffer_load_dwordx4 v[120:123], v21, s[4:7], s54 offen sc1
    v_mfma_f32_32x32x16_bf16 a[32:47], v[88:91], v[76:79], a[32:47]
    buffer_load_dwordx4 v[124:127], v21, s[4:7], s55 offen sc1
    v_mfma_f32_32x32x16_bf16 a[48:63], v[88:91], v[80:83], a[48:63]
    buffer_load_dwordx4 v[128:131], v21, s[4:7], s55 offen offset:1024 sc1
    v_mfma_f32_32x32x16_bf16 v[156:171], v[92:95], v[76:79], v[156:171]
    buffer_load_dwordx4 v[132:135], v24, s[4:7], s55 offen offset:2048 sc1
    v_mfma_f32_32x32x16_bf16 v[172:187], v[92:95], v[80:83], v[172:187]
    s_add_u32 s53, s53, 1024
    s_add_u32 s54, s54, 1024
    s_add_u32 s55, s55, 2560
    s_waitcnt vmcnt(5)
    v_mfma_f32_32x32x16_bf16 a[0:15], v[104:107], v[96:99], a[0:15]
    v_mfma_f32_32x32x16_bf16 a[16:31], v[104:107], v[100:103], a[16:31]
    v_mfma_f32_32x32x16_bf16 a[32:47], v[108:111], v[96:99], a[32:47]
    v_mfma_f32_32x32x16_bf16 a[48:63], v[108:111], v[100:103], a[48:63]
    v_mfma_f32_32x32x16_bf16 v[156:171], v[112:115], v[96:99], v[156:171]
    v_mfma_f32_32x32x16_bf16 v[172:187], v[112:115], v[100:103], v[172:187]
    s_waitcnt vmcnt(0)
    v_mfma_f32_32x32x16_bf16 a[0:15], v[124:127], v[116:119], a[0:15]
    v_mfma_f32_32x32x16_bf16 a[16:31], v[124:127], v[120:123], a[16:31]
    v_mfma_f32_32x32x16_bf16 a[32:47], v[128:131], v[116:119], a[32:47]
    v_mfma_f32_32x32x16_bf16 a[48:63], v[128:131], v[120:123], a[48:63]
    v_mfma_f32_32x32x16_bf16 v[156:171], v[132:135], v[116:119], v[156:171]
    v_mfma_f32_32x32x16_bf16 v[172:187], v[132:135], v[120:123], v[172:187]
    s_mov_b32 s65, s53
    s_mov_b32 s66, s54
    s_mov_b32 s67, s55
    s_lshl_b32 s60, s52, 3
    s_add_u32 s60, s60, s56
    s_add_u32 s60, s60, 96
    s_mul_i32 s53, s60, 2560
    s_add_u32 s53, s53, 19922944
    s_lshl_b32 s60, s52, 1
    s_add_u32 s60, s60, s56
    s_add_u32 s60, s60, 128
    s_mul_i32 s54, s60, 2560
    s_add_u32 s54, s54, 19922944
    s_waitcnt vmcnt(0)
    buffer_load_dwordx4 v[76:79], v21, s[4:7], s53 offen offset:0 sc1
    buffer_load_dwordx4 v[80:83], v21, s[4:7], s53 offen offset:1024 sc1
    buffer_load_dwordx4 v[84:87], v21, s[4:7], s53 offen offset:2048 sc1
    s_waitcnt vmcnt(2) lgkmcnt(0)
    ds_write_b128 v8, v[76:79] offset:0
    buffer_load_dwordx4 v[88:91], v21, s[4:7], s53 offen offset:3072 sc1
    s_waitcnt vmcnt(2) lgkmcnt(0)
    ds_write_b128 v8, v[80:83] offset:1024
    buffer_load_dwordx4 v[76:79], v23, s[4:7], s53 offen offset:0 sc1
    s_waitcnt vmcnt(2) lgkmcnt(0)
    ds_write_b128 v8, v[84:87] offset:2048
    buffer_load_dwordx4 v[80:83], v23, s[4:7], s53 offen offset:1024 sc1
    s_waitcnt vmcnt(2) lgkmcnt(0)
    ds_write_b128 v8, v[88:91] offset:3072
    buffer_load_dwordx4 v[84:87], v23, s[4:7], s53 offen offset:2048 sc1
    s_waitcnt vmcnt(2) lgkmcnt(0)
    ds_write_b128 v8, v[76:79] offset:4096
    buffer_load_dwordx4 v[88:91], v23, s[4:7], s53 offen offset:3072 sc1
    s_waitcnt vmcnt(2) lgkmcnt(0)
    ds_write_b128 v8, v[80:83] offset:5120
    s_add_u32 s53, s53, 8192
    buffer_load_dwordx4 v[76:79], v21, s[4:7], s53 offen offset:0 sc1
    s_waitcnt vmcnt(2) lgkmcnt(0)
    ds_write_b128 v8, v[84:87] offset:6144
    buffer_load_dwordx4 v[80:83], v21, s[4:7], s53 offen offset:1024 sc1
    s_waitcnt vmcnt(2) lgkmcnt(0)
    ds_write_b128 v8, v[88:91] offset:7168
    buffer_load_dwordx4 v[84:87], v21, s[4:7], s53 offen offset:2048 sc1
    s_waitcnt vmcnt(2) lgkmcnt(0)
    ds_write_b128 v8, v[76:79] offset:8192
    buffer_load_dwordx4 v[88:91], v21, s[4:7], s53 offen offset:3072 sc1
    s_waitcnt vmcnt(2) lgkmcnt(0)
    ds_write_b128 v8, v[80:83] offset:9216
    buffer_load_dwordx4 v[76:79], v23, s[4:7], s53 offen offset:0 sc1
    s_waitcnt vmcnt(2) lgkmcnt(0)
    ds_write_b128 v8, v[84:87] offset:10240
    buffer_load_dwordx4 v[80:83], v23, s[4:7], s53 offen offset:1024 sc1
    s_waitcnt vmcnt(2) lgkmcnt(0)
    ds_write_b128 v8, v[88:91] offset:11264
    buffer_load_dwordx4 v[84:87], v23, s[4:7], s53 offen offset:2048 sc1
    s_waitcnt vmcnt(2) lgkmcnt(0)
    ds_write_b128 v8, v[76:79] offset:12288
    buffer_load_dwordx4 v[88:91], v23, s[4:7], s53 offen offset:3072 sc1
    s_waitcnt vmcnt(2) lgkmcnt(0)
    ds_write_b128 v8, v[80:83] offset:13312
    s_add_u32 s53, s53, 8192
    buffer_load_dwordx4 v[76:79], v21, s[4:7], s53 offen offset:0 sc1
    s_waitcnt vmcnt(2) lgkmcnt(0)
    ds_write_b128 v8, v[84:87] offset:14336
    buffer_load_dwordx4 v[80:83], v21, s[4:7], s53 offen offset:1024 sc1
    s_waitcnt vmcnt(2) lgkmcnt(0)
    ds_write_b128 v8, v[88:91] offset:15360
    buffer_load_dwordx4 v[84:87], v21, s[4:7], s53 offen offset:2048 sc1
    s_waitcnt vmcnt(2) lgkmcnt(0)
    ds_write_b128 v8, v[76:79] offset:16384
    buffer_load_dwordx4 v[88:91], v21, s[4:7], s53 offen offset:3072 sc1
    s_waitcnt vmcnt(2) lgkmcnt(0)
    ds_write_b128 v8, v[80:83] offset:17408
    buffer_load_dwordx4 v[76:79], v21, s[4:7], s54 offen offset:0 sc1
    s_waitcnt vmcnt(2) lgkmcnt(0)
    ds_write_b128 v8, v[84:87] offset:18432
    buffer_load_dwordx4 v[80:83], v21, s[4:7], s54 offen offset:1024 sc1
    s_waitcnt vmcnt(2) lgkmcnt(0)
    ds_write_b128 v8, v[88:91] offset:19456
    buffer_load_dwordx4 v[84:87], v21, s[4:7], s54 offen offset:2048 sc1
    s_waitcnt vmcnt(2) lgkmcnt(0)
    ds_write_b128 v8, v[76:79] offset:20480
    buffer_load_dwordx4 v[88:91], v21, s[4:7], s54 offen offset:3072 sc1
    s_waitcnt vmcnt(2) lgkmcnt(0)
    ds_write_b128 v8, v[80:83] offset:21504
    buffer_load_dwordx4 v[76:79], v23, s[4:7], s54 offen offset:0 sc1
    s_waitcnt vmcnt(2) lgkmcnt(0)
    ds_write_b128 v8, v[84:87] offset:22528
    s_waitcnt vmcnt(1) lgkmcnt(0)
    ds_write_b128 v8, v[88:91] offset:23552
    s_waitcnt vmcnt(0) lgkmcnt(0)
    ds_write_b128 v8, v[76:79] offset:24576
    s_mov_b32 s53, s65
    s_mov_b32 s54, s66
    s_mov_b32 s55, s67
    s_waitcnt lgkmcnt(0)
    buffer_load_dwordx4 v[76:79], v21, s[4:7], s53 offen sc1
    buffer_load_dwordx4 v[80:83], v21, s[4:7], s54 offen sc1
    buffer_load_dwordx4 v[84:87], v21, s[4:7], s55 offen sc1
    buffer_load_dwordx4 v[88:91], v21, s[4:7], s55 offen offset:1024 sc1
    buffer_load_dwordx4 v[92:95], v24, s[4:7], s55 offen offset:2048 sc1
    s_add_u32 s53, s53, 1024
    s_add_u32 s54, s54, 1024
    s_add_u32 s55, s55, 2560
    buffer_load_dwordx4 v[96:99], v21, s[4:7], s53 offen sc1
    buffer_load_dwordx4 v[100:103], v21, s[4:7], s54 offen sc1
    buffer_load_dwordx4 v[104:107], v21, s[4:7], s55 offen sc1
    buffer_load_dwordx4 v[108:111], v21, s[4:7], s55 offen offset:1024 sc1
    buffer_load_dwordx4 v[112:115], v24, s[4:7], s55 offen offset:2048 sc1
    s_add_u32 s53, s53, 1024
    s_add_u32 s54, s54, 1024
    s_add_u32 s55, s55, 2560
    s_lshl_b32 s60, s50, 8
    s_lshl_b32 s61, s52, 6
    s_add_u32 s60, s60, s61
    s_add_u32 s63, s60, 24141824
    s_waitcnt lgkmcnt(0)
    s_barrier
    ds_read_b32 v6, v12
    s_waitcnt lgkmcnt(0)
    v_readfirstlane_b32 s60, v6
    s_cmp_eq_u32 s60, 0
    s_cbranch_scc1 parallel_sum__softmax_full_mha__mixer_channel_mlp__prompt_kernel_noredo
    s_barrier
    s_barrier
    s_barrier
parallel_sum__softmax_full_mha__mixer_channel_mlp__prompt_kernel_noredo:
    s_mov_b32 s60, 0
parallel_sum__softmax_full_mha__mixer_channel_mlp__prompt_kernel_gl_30:
    s_waitcnt vmcnt(5)
    v_mfma_f32_32x32x16_bf16 a[0:15], v[84:87], v[76:79], a[0:15]
    buffer_load_dwordx4 v[116:119], v21, s[4:7], s53 offen sc1
    v_mfma_f32_32x32x16_bf16 a[16:31], v[84:87], v[80:83], a[16:31]
    buffer_load_dwordx4 v[120:123], v21, s[4:7], s54 offen sc1
    v_mfma_f32_32x32x16_bf16 a[32:47], v[88:91], v[76:79], a[32:47]
    buffer_load_dwordx4 v[124:127], v21, s[4:7], s55 offen sc1
    v_mfma_f32_32x32x16_bf16 a[48:63], v[88:91], v[80:83], a[48:63]
    buffer_load_dwordx4 v[128:131], v21, s[4:7], s55 offen offset:1024 sc1
    v_mfma_f32_32x32x16_bf16 v[156:171], v[92:95], v[76:79], v[156:171]
    buffer_load_dwordx4 v[132:135], v24, s[4:7], s55 offen offset:2048 sc1
    v_mfma_f32_32x32x16_bf16 v[172:187], v[92:95], v[80:83], v[172:187]
    s_add_u32 s53, s53, 1024
    s_add_u32 s54, s54, 1024
    s_add_u32 s55, s55, 2560
    s_waitcnt vmcnt(5)
    v_mfma_f32_32x32x16_bf16 a[0:15], v[104:107], v[96:99], a[0:15]
    buffer_load_dwordx4 v[76:79], v21, s[4:7], s53 offen sc1
    v_mfma_f32_32x32x16_bf16 a[16:31], v[104:107], v[100:103], a[16:31]
    buffer_load_dwordx4 v[80:83], v21, s[4:7], s54 offen sc1
    v_mfma_f32_32x32x16_bf16 a[32:47], v[108:111], v[96:99], a[32:47]
    buffer_load_dwordx4 v[84:87], v21, s[4:7], s55 offen sc1
    v_mfma_f32_32x32x16_bf16 a[48:63], v[108:111], v[100:103], a[48:63]
    buffer_load_dwordx4 v[88:91], v21, s[4:7], s55 offen offset:1024 sc1
    v_mfma_f32_32x32x16_bf16 v[156:171], v[112:115], v[96:99], v[156:171]
    buffer_load_dwordx4 v[92:95], v24, s[4:7], s55 offen offset:2048 sc1
    v_mfma_f32_32x32x16_bf16 v[172:187], v[112:115], v[100:103], v[172:187]
    s_add_u32 s53, s53, 1024
    s_add_u32 s54, s54, 1024
    s_add_u32 s55, s55, 2560
    s_waitcnt vmcnt(5)
    v_mfma_f32_32x32x16_bf16 a[0:15], v[124:127], v[116:119], a[0:15]
    buffer_load_dwordx4 v[96:99], v21, s[4:7], s53 offen sc1
    v_mfma_f32_32x32x16_bf16 a[16:31], v[124:127], v[120:123], a[16:31]
    buffer_load_dwordx4 v[100:103], v21, s[4:7], s54 offen sc1
    v_mfma_f32_32x32x16_bf16 a[32:47], v[128:131], v[116:119], a[32:47]
    buffer_load_dwordx4 v[104:107], v21, s[4:7], s55 offen sc1
    v_mfma_f32_32x32x16_bf16 a[48:63], v[128:131], v[120:123], a[48:63]
    buffer_load_dwordx4 v[108:111], v21, s[4:7], s55 offen offset:1024 sc1
    v_mfma_f32_32x32x16_bf16 v[156:171], v[132:135], v[116:119], v[156:171]
    buffer_load_dwordx4 v[112:115], v24, s[4:7], s55 offen offset:2048 sc1
    v_mfma_f32_32x32x16_bf16 v[172:187], v[132:135], v[120:123], v[172:187]
    s_add_u32 s53, s53, 1024
    s_add_u32 s54, s54, 1024
    s_add_u32 s55, s55, 2560
    s_add_u32 s60, s60, 1
    s_cmp_lt_u32 s60, 1
    s_cbranch_scc1 parallel_sum__softmax_full_mha__mixer_channel_mlp__prompt_kernel_gl_30
    s_waitcnt vmcnt(5)
    v_mfma_f32_32x32x16_bf16 a[0:15], v[84:87], v[76:79], a[0:15]
    buffer_load_dwordx4 v[116:119], v21, s[4:7], s53 offen sc1
    v_mfma_f32_32x32x16_bf16 a[16:31], v[84:87], v[80:83], a[16:31]
    buffer_load_dwordx4 v[120:123], v21, s[4:7], s54 offen sc1
    v_mfma_f32_32x32x16_bf16 a[32:47], v[88:91], v[76:79], a[32:47]
    buffer_load_dwordx4 v[124:127], v21, s[4:7], s55 offen sc1
    v_mfma_f32_32x32x16_bf16 a[48:63], v[88:91], v[80:83], a[48:63]
    buffer_load_dwordx4 v[128:131], v21, s[4:7], s55 offen offset:1024 sc1
    v_mfma_f32_32x32x16_bf16 v[156:171], v[92:95], v[76:79], v[156:171]
    buffer_load_dwordx4 v[132:135], v24, s[4:7], s55 offen offset:2048 sc1
    v_mfma_f32_32x32x16_bf16 v[172:187], v[92:95], v[80:83], v[172:187]
    s_add_u32 s53, s53, 1024
    s_add_u32 s54, s54, 1024
    s_add_u32 s55, s55, 2560
    s_waitcnt vmcnt(5)
    v_mfma_f32_32x32x16_bf16 a[0:15], v[104:107], v[96:99], a[0:15]
    v_mfma_f32_32x32x16_bf16 a[16:31], v[104:107], v[100:103], a[16:31]
    v_mfma_f32_32x32x16_bf16 a[32:47], v[108:111], v[96:99], a[32:47]
    v_mfma_f32_32x32x16_bf16 a[48:63], v[108:111], v[100:103], a[48:63]
    v_mfma_f32_32x32x16_bf16 v[156:171], v[112:115], v[96:99], v[156:171]
    v_mfma_f32_32x32x16_bf16 v[172:187], v[112:115], v[100:103], v[172:187]
    s_waitcnt vmcnt(0)
    v_mfma_f32_32x32x16_bf16 a[0:15], v[124:127], v[116:119], a[0:15]
    v_mfma_f32_32x32x16_bf16 a[16:31], v[124:127], v[120:123], a[16:31]
    v_mfma_f32_32x32x16_bf16 a[32:47], v[128:131], v[116:119], a[32:47]
    v_mfma_f32_32x32x16_bf16 a[48:63], v[128:131], v[120:123], a[48:63]
    v_mfma_f32_32x32x16_bf16 v[156:171], v[132:135], v[116:119], v[156:171]
    v_mfma_f32_32x32x16_bf16 v[172:187], v[132:135], v[120:123], v[172:187]
    s_mul_i32 s60, s50, 81920
    s_lshl_b32 s53, s52, 13
    s_add_u32 s53, s53, s60
    s_add_u32 s53, s53, 16777216
    s_add_u32 s54, s53, 40960
    s_lshl_b32 s55, s52, 11
    s_add_u32 s55, s55, s60
    s_add_u32 s55, s55, 16809984
    s_add_u32 s56, s55, 40960
    s_mov_b32 s68, 100000
parallel_sum__softmax_full_mha__mixer_channel_mlp__prompt_kernel_fo_p_31:
    buffer_load_dwordx2 v[48:49], v11, s[4:7], s63 offen sc1
    s_sub_u32 s68, s68, 1
    s_cmp_eq_u32 s68, 0
    s_cbranch_scc1 parallel_sum__softmax_full_mha__mixer_channel_mlp__prompt_kernel_fo_g_32
    s_waitcnt vmcnt(0)
    v_cmp_ne_u64 vcc, v[18:19], v[48:49]
    s_cbranch_vccz parallel_sum__softmax_full_mha__mixer_channel_mlp__prompt_kernel_fo_g_32
    s_sleep 1
    s_branch parallel_sum__softmax_full_mha__mixer_channel_mlp__prompt_kernel_fo_p_31
parallel_sum__softmax_full_mha__mixer_channel_mlp__prompt_kernel_fo_g_32:
    buffer_load_dwordx4 v[76:79], v21, s[4:7], s53 offen offset:0 sc1
    buffer_load_dwordx4 v[80:83], v21, s[4:7], s54 offen offset:0 sc1
    buffer_load_dwordx4 v[84:87], v21, s[4:7], s53 offen offset:1024 sc1
    buffer_load_dwordx4 v[88:91], v21, s[4:7], s54 offen offset:1024 sc1
    buffer_load_dwordx4 v[92:95], v21, s[4:7], s53 offen offset:2048 sc1
    buffer_load_dwordx4 v[96:99], v21, s[4:7], s54 offen offset:2048 sc1
    buffer_load_dwordx4 v[100:103], v21, s[4:7], s53 offen offset:3072 sc1
    buffer_load_dwordx4 v[104:107], v21, s[4:7], s54 offen offset:3072 sc1
    buffer_load_dwordx4 v[108:111], v23, s[4:7], s53 offen offset:0 sc1
    buffer_load_dwordx4 v[112:115], v23, s[4:7], s54 offen offset:0 sc1
    buffer_load_dwordx4 v[116:119], v23, s[4:7], s53 offen offset:1024 sc1
    buffer_load_dwordx4 v[120:123], v23, s[4:7], s54 offen offset:1024 sc1
    buffer_load_dwordx4 v[124:127], v23, s[4:7], s53 offen offset:2048 sc1
    buffer_load_dwordx4 v[128:131], v23, s[4:7], s54 offen offset:2048 sc1
    buffer_load_dwordx4 v[132:135], v23, s[4:7], s53 offen offset:3072 sc1
    buffer_load_dwordx4 v[136:139], v23, s[4:7], s54 offen offset:3072 sc1
    buffer_load_dwordx4 v[140:143], v21, s[4:7], s55 offen offset:0 sc1
    buffer_load_dwordx4 v[144:147], v21, s[4:7], s56 offen offset:0 sc1
    buffer_load_dwordx4 v[148:151], v21, s[4:7], s55 offen offset:1024 sc1
    buffer_load_dwordx4 v[152:155], v21, s[4:7], s56 offen offset:1024 sc1
    ds_read_b128 v[26:29], v8 offset:0
    ds_read_b128 v[30:33], v8 offset:1024
    ds_read_b128 v[34:37], v9 offset:2048
    s_waitcnt vmcnt(18)
    s_waitcnt lgkmcnt(2)
    v_mfma_f32_32x32x16_bf16 a[0:15], v[26:29], v[76:79], a[0:15]
    v_mfma_f32_32x32x16_bf16 a[16:31], v[26:29], v[80:83], a[16:31]
    ds_read_b128 v[26:29], v8 offset:2560
    s_waitcnt lgkmcnt(2)
    v_mfma_f32_32x32x16_bf16 a[32:47], v[30:33], v[76:79], a[32:47]
    v_mfma_f32_32x32x16_bf16 a[48:63], v[30:33], v[80:83], a[48:63]
    ds_read_b128 v[30:33], v8 offset:3584
    s_waitcnt lgkmcnt(2)
    v_mfma_f32_32x32x16_bf16 v[156:171], v[34:37], v[76:79], v[156:171]
    v_mfma_f32_32x32x16_bf16 v[172:187], v[34:37], v[80:83], v[172:187]
    ds_read_b128 v[34:37], v9 offset:4608
    s_waitcnt vmcnt(16)
    s_waitcnt lgkmcnt(2)
    v_mfma_f32_32x32x16_bf16 a[0:15], v[26:29], v[84:87], a[0:15]
    v_mfma_f32_32x32x16_bf16 a[16:31], v[26:29], v[88:91], a[16:31]
    ds_read_b128 v[26:29], v8 offset:5120
    s_waitcnt lgkmcnt(2)
    v_mfma_f32_32x32x16_bf16 a[32:47], v[30:33], v[84:87], a[32:47]
    v_mfma_f32_32x32x16_bf16 a[48:63], v[30:33], v[88:91], a[48:63]
    ds_read_b128 v[30:33], v8 offset:6144
    s_waitcnt lgkmcnt(2)
    v_mfma_f32_32x32x16_bf16 v[156:171], v[34:37], v[84:87], v[156:171]
    v_mfma_f32_32x32x16_bf16 v[172:187], v[34:37], v[88:91], v[172:187]
    ds_read_b128 v[34:37], v9 offset:7168
    s_waitcnt vmcnt(14)
    s_waitcnt lgkmcnt(2)
    v_mfma_f32_32x32x16_bf16 a[0:15], v[26:29], v[92:95], a[0:15]
    v_mfma_f32_32x32x16_bf16 a[16:31], v[26:29], v[96:99], a[16:31]
    ds_read_b128 v[26:29], v8 offset:7680
    s_waitcnt lgkmcnt(2)
    v_mfma_f32_32x32x16_bf16 a[32:47], v[30:33], v[92:95], a[32:47]
    v_mfma_f32_32x32x16_bf16 a[48:63], v[30:33], v[96:99], a[48:63]
    ds_read_b128 v[30:33], v8 offset:8704
    s_waitcnt lgkmcnt(2)
    v_mfma_f32_32x32x16_bf16 v[156:171], v[34:37], v[92:95], v[156:171]
    v_mfma_f32_32x32x16_bf16 v[172:187], v[34:37], v[96:99], v[172:187]
    ds_read_b128 v[34:37], v9 offset:9728
    s_waitcnt vmcnt(12)
    s_waitcnt lgkmcnt(2)
    v_mfma_f32_32x32x16_bf16 a[0:15], v[26:29], v[100:103], a[0:15]
    v_mfma_f32_32x32x16_bf16 a[16:31], v[26:29], v[104:107], a[16:31]
    ds_read_b128 v[26:29], v8 offset:10240
    s_waitcnt lgkmcnt(2)
    v_mfma_f32_32x32x16_bf16 a[32:47], v[30:33], v[100:103], a[32:47]
    v_mfma_f32_32x32x16_bf16 a[48:63], v[30:33], v[104:107], a[48:63]
    ds_read_b128 v[30:33], v8 offset:11264
    s_waitcnt lgkmcnt(2)
    v_mfma_f32_32x32x16_bf16 v[156:171], v[34:37], v[100:103], v[156:171]
    v_mfma_f32_32x32x16_bf16 v[172:187], v[34:37], v[104:107], v[172:187]
    ds_read_b128 v[34:37], v9 offset:12288
    s_waitcnt vmcnt(10)
    s_waitcnt lgkmcnt(2)
    v_mfma_f32_32x32x16_bf16 a[0:15], v[26:29], v[108:111], a[0:15]
    v_mfma_f32_32x32x16_bf16 a[16:31], v[26:29], v[112:115], a[16:31]
    ds_read_b128 v[26:29], v8 offset:12800
    s_waitcnt lgkmcnt(2)
    v_mfma_f32_32x32x16_bf16 a[32:47], v[30:33], v[108:111], a[32:47]
    v_mfma_f32_32x32x16_bf16 a[48:63], v[30:33], v[112:115], a[48:63]
    ds_read_b128 v[30:33], v8 offset:13824
    s_waitcnt lgkmcnt(2)
    v_mfma_f32_32x32x16_bf16 v[156:171], v[34:37], v[108:111], v[156:171]
    v_mfma_f32_32x32x16_bf16 v[172:187], v[34:37], v[112:115], v[172:187]
    ds_read_b128 v[34:37], v9 offset:14848
    s_waitcnt vmcnt(8)
    s_waitcnt lgkmcnt(2)
    v_mfma_f32_32x32x16_bf16 a[0:15], v[26:29], v[116:119], a[0:15]
    v_mfma_f32_32x32x16_bf16 a[16:31], v[26:29], v[120:123], a[16:31]
    ds_read_b128 v[26:29], v8 offset:15360
    s_waitcnt lgkmcnt(2)
    v_mfma_f32_32x32x16_bf16 a[32:47], v[30:33], v[116:119], a[32:47]
    v_mfma_f32_32x32x16_bf16 a[48:63], v[30:33], v[120:123], a[48:63]
    ds_read_b128 v[30:33], v8 offset:16384
    s_waitcnt lgkmcnt(2)
    v_mfma_f32_32x32x16_bf16 v[156:171], v[34:37], v[116:119], v[156:171]
    v_mfma_f32_32x32x16_bf16 v[172:187], v[34:37], v[120:123], v[172:187]
    ds_read_b128 v[34:37], v9 offset:17408
    s_waitcnt vmcnt(6)
    s_waitcnt lgkmcnt(2)
    v_mfma_f32_32x32x16_bf16 a[0:15], v[26:29], v[124:127], a[0:15]
    v_mfma_f32_32x32x16_bf16 a[16:31], v[26:29], v[128:131], a[16:31]
    ds_read_b128 v[26:29], v8 offset:17920
    s_waitcnt lgkmcnt(2)
    v_mfma_f32_32x32x16_bf16 a[32:47], v[30:33], v[124:127], a[32:47]
    v_mfma_f32_32x32x16_bf16 a[48:63], v[30:33], v[128:131], a[48:63]
    ds_read_b128 v[30:33], v8 offset:18944
    s_waitcnt lgkmcnt(2)
    v_mfma_f32_32x32x16_bf16 v[156:171], v[34:37], v[124:127], v[156:171]
    v_mfma_f32_32x32x16_bf16 v[172:187], v[34:37], v[128:131], v[172:187]
    ds_read_b128 v[34:37], v9 offset:19968
    s_waitcnt vmcnt(4)
    s_waitcnt lgkmcnt(2)
    v_mfma_f32_32x32x16_bf16 a[0:15], v[26:29], v[132:135], a[0:15]
    v_mfma_f32_32x32x16_bf16 a[16:31], v[26:29], v[136:139], a[16:31]
    ds_read_b128 v[26:29], v8 offset:20480
    s_waitcnt lgkmcnt(2)
    v_mfma_f32_32x32x16_bf16 a[32:47], v[30:33], v[132:135], a[32:47]
    v_mfma_f32_32x32x16_bf16 a[48:63], v[30:33], v[136:139], a[48:63]
    ds_read_b128 v[30:33], v8 offset:21504
    s_waitcnt lgkmcnt(2)
    v_mfma_f32_32x32x16_bf16 v[156:171], v[34:37], v[132:135], v[156:171]
    v_mfma_f32_32x32x16_bf16 v[172:187], v[34:37], v[136:139], v[172:187]
    ds_read_b128 v[34:37], v9 offset:22528
    s_waitcnt vmcnt(2)
    s_waitcnt lgkmcnt(2)
    v_mfma_f32_32x32x16_bf16 a[0:15], v[26:29], v[140:143], a[0:15]
    v_mfma_f32_32x32x16_bf16 a[16:31], v[26:29], v[144:147], a[16:31]
    ds_read_b128 v[26:29], v8 offset:23040
    s_waitcnt lgkmcnt(2)
    v_mfma_f32_32x32x16_bf16 a[32:47], v[30:33], v[140:143], a[32:47]
    v_mfma_f32_32x32x16_bf16 a[48:63], v[30:33], v[144:147], a[48:63]
    ds_read_b128 v[30:33], v8 offset:24064
    s_waitcnt lgkmcnt(2)
    v_mfma_f32_32x32x16_bf16 v[156:171], v[34:37], v[140:143], v[156:171]
    v_mfma_f32_32x32x16_bf16 v[172:187], v[34:37], v[144:147], v[172:187]
    ds_read_b128 v[34:37], v9 offset:25088
    s_waitcnt vmcnt(0)
    s_waitcnt lgkmcnt(2)
    v_mfma_f32_32x32x16_bf16 a[0:15], v[26:29], v[148:151], a[0:15]
    v_mfma_f32_32x32x16_bf16 a[16:31], v[26:29], v[152:155], a[16:31]
    s_waitcnt lgkmcnt(1)
    v_mfma_f32_32x32x16_bf16 a[32:47], v[30:33], v[148:151], a[32:47]
    v_mfma_f32_32x32x16_bf16 a[48:63], v[30:33], v[152:155], a[48:63]
    s_waitcnt lgkmcnt(0)
    v_mfma_f32_32x32x16_bf16 v[156:171], v[34:37], v[148:151], v[156:171]
    v_mfma_f32_32x32x16_bf16 v[172:187], v[34:37], v[152:155], v[172:187]
    s_nop 7
    ds_write_b128 v10, a[0:3] offset:0
    ds_write_b128 v10, a[4:7] offset:32
    ds_write_b128 v10, a[8:11] offset:64
    ds_write_b128 v10, a[12:15] offset:96
    ds_write_b128 v10, a[16:19] offset:10752
    ds_write_b128 v10, a[20:23] offset:10784
    ds_write_b128 v10, a[24:27] offset:10816
    ds_write_b128 v10, a[28:31] offset:10848
    ds_write_b128 v10, a[32:35] offset:128
    ds_write_b128 v10, a[36:39] offset:160
    ds_write_b128 v10, a[40:43] offset:192
    ds_write_b128 v10, a[44:47] offset:224
    ds_write_b128 v10, a[48:51] offset:10880
    ds_write_b128 v10, a[52:55] offset:10912
    ds_write_b128 v10, a[56:59] offset:10944
    ds_write_b128 v10, a[60:63] offset:10976
    ds_write_b128 v10, v[156:159] offset:256
    ds_write_b128 v10, v[160:163] offset:288
    ds_write_b128 v10, v[172:175] offset:11008
    ds_write_b128 v10, v[176:179] offset:11040
    s_waitcnt lgkmcnt(0)
    s_barrier
    v_add_u32 v13, 51200, v38
    v_add_u32 v14, 51200, v39
    v_add_u32 v15, 51200, v40
    v_add_u32 v16, 51200, v41
    v_add_u32 v17, 51200, v42
    ds_read_b128 v[76:79], v38 offset:0
    ds_read_b128 v[80:83], v38 offset:25600
    ds_read_b128 v[84:87], v13 offset:0
    ds_read_b128 v[88:91], v13 offset:25600
    ds_read_b128 v[92:95], v39 offset:0
    ds_read_b128 v[96:99], v39 offset:25600
    ds_read_b128 v[100:103], v14 offset:0
    ds_read_b128 v[104:107], v14 offset:25600
    ds_read_b128 v[108:111], v40 offset:0
    ds_read_b128 v[112:115], v40 offset:25600
    ds_read_b128 v[116:119], v15 offset:0
    ds_read_b128 v[120:123], v15 offset:25600
    ds_read_b128 v[124:127], v41 offset:0
    ds_read_b128 v[128:131], v41 offset:25600
    ds_read_b128 v[132:135], v16 offset:0
    ds_read_b128 v[136:139], v16 offset:25600
    ds_read_b128 v[140:143], v42 offset:0
    ds_read_b128 v[144:147], v42 offset:25600
    ds_read_b128 v[148:151], v17 offset:0
    ds_read_b128 v[152:155], v17 offset:25600
    s_waitcnt lgkmcnt(15)
    v_pk_add_f32 v[76:77], v[76:77], v[80:81]
    v_pk_add_f32 v[84:85], v[84:85], v[88:89]
    v_pk_add_f32 v[78:79], v[78:79], v[82:83]
    v_pk_add_f32 v[86:87], v[86:87], v[90:91]
    v_pk_add_f32 v[76:77], v[76:77], v[54:55]
    v_pk_add_f32 v[78:79], v[78:79], v[56:57]
    v_pk_add_f32 v[76:77], v[76:77], v[84:85]
    v_pk_add_f32 v[78:79], v[78:79], v[86:87]
    v_cvt_pk_bf16_f32 v80, v76, v77
    v_cvt_pk_bf16_f32 v81, v78, v79
    buffer_store_dwordx2 v[80:81], v43, s[16:19], s58 offen
    s_waitcnt lgkmcnt(12)
    v_pk_add_f32 v[92:93], v[92:93], v[96:97]
    v_pk_add_f32 v[100:101], v[100:101], v[104:105]
    v_pk_add_f32 v[94:95], v[94:95], v[98:99]
    v_pk_add_f32 v[102:103], v[102:103], v[106:107]
    v_pk_add_f32 v[92:93], v[92:93], v[58:59]
    v_pk_add_f32 v[94:95], v[94:95], v[60:61]
    v_pk_add_f32 v[92:93], v[92:93], v[100:101]
    v_pk_add_f32 v[94:95], v[94:95], v[102:103]
    v_cvt_pk_bf16_f32 v96, v92, v93
    v_cvt_pk_bf16_f32 v97, v94, v95
    buffer_store_dwordx2 v[96:97], v44, s[16:19], s58 offen
    s_waitcnt lgkmcnt(8)
    v_pk_add_f32 v[108:109], v[108:109], v[112:113]
    v_pk_add_f32 v[116:117], v[116:117], v[120:121]
    v_pk_add_f32 v[110:111], v[110:111], v[114:115]
    v_pk_add_f32 v[118:119], v[118:119], v[122:123]
    v_pk_add_f32 v[108:109], v[108:109], v[62:63]
    v_pk_add_f32 v[110:111], v[110:111], v[64:65]
    v_pk_add_f32 v[108:109], v[108:109], v[116:117]
    v_pk_add_f32 v[110:111], v[110:111], v[118:119]
    v_cvt_pk_bf16_f32 v112, v108, v109
    v_cvt_pk_bf16_f32 v113, v110, v111
    buffer_store_dwordx2 v[112:113], v45, s[16:19], s58 offen
    s_waitcnt lgkmcnt(4)
    v_pk_add_f32 v[124:125], v[124:125], v[128:129]
    v_pk_add_f32 v[132:133], v[132:133], v[136:137]
    v_pk_add_f32 v[126:127], v[126:127], v[130:131]
    v_pk_add_f32 v[134:135], v[134:135], v[138:139]
    v_pk_add_f32 v[124:125], v[124:125], v[66:67]
    v_pk_add_f32 v[126:127], v[126:127], v[68:69]
    v_pk_add_f32 v[124:125], v[124:125], v[132:133]
    v_pk_add_f32 v[126:127], v[126:127], v[134:135]
    v_cvt_pk_bf16_f32 v128, v124, v125
    v_cvt_pk_bf16_f32 v129, v126, v127
    buffer_store_dwordx2 v[128:129], v46, s[16:19], s58 offen
    s_waitcnt lgkmcnt(0)
    v_pk_add_f32 v[140:141], v[140:141], v[144:145]
    v_pk_add_f32 v[148:149], v[148:149], v[152:153]
    v_pk_add_f32 v[142:143], v[142:143], v[146:147]
    v_pk_add_f32 v[150:151], v[150:151], v[154:155]
    v_pk_add_f32 v[140:141], v[140:141], v[70:71]
    v_pk_add_f32 v[142:143], v[142:143], v[72:73]
    v_pk_add_f32 v[140:141], v[140:141], v[148:149]
    v_pk_add_f32 v[142:143], v[142:143], v[150:151]
    v_cvt_pk_bf16_f32 v144, v140, v141
    v_cvt_pk_bf16_f32 v145, v142, v143
    buffer_store_dwordx2 v[144:145], v47, s[16:19], s58 offen
    s_endpgm
parallel_sum__softmax_full_mha__mixer_channel_mlp__prompt_kernel_A:
    s_and_b32 s52, s3, 1
    s_lshr_b32 s53, s3, 1
    s_lshl_b32 s60, s52, 6
    s_lshl_b32 s61, s53, 5
    s_add_u32 s60, s60, s61
    v_add_u32 v4, s60, v2
    v_lshrrev_b32 v5, 1, v4
    v_and_b32 v5, 7, v5
    v_xor_b32 v5, v5, v3
    v_lshlrev_b32 v5, 4, v5
    v_lshl_add_u32 v18, v4, 7, v5
    v_xor_b32 v19, 32, v18
    v_xor_b32 v20, 64, v18
    v_xor_b32 v21, 96, v18
    v_xor_b32 v22, 0x1000, v18
    v_xor_b32 v23, 0x1000, v19
    v_xor_b32 v24, 0x1000, v20
    v_xor_b32 v25, 0x1000, v21
    v_bfe_u32 v4, v1, 2, 2
    v_and_b32 v5, 3, v1
    v_bfe_u32 v6, v1, 4, 1
    v_lshlrev_b32 v8, 5, v6
    v_lshl_add_u32 v8, v5, 3, v8
    v_lshl_add_u32 v9, v3, 3, v4
    s_mul_i32 s60, s53, 120
    v_lshlrev_b32 v10, 8, v9
    v_add_u32 v10, 49152, v10
    v_add_u32 v11, s60, v8
    v_lshrrev_b32 v12, 6, v11
    v_xor_b32 v12, v12, v4
    v_and_b32 v11, 63, v11
    v_lshl_add_u32 v11, v12, 6, v11
    v_add_u32 v26, v11, v10
    v_add_u32 v11, s60, v8
    v_add_u32 v11, 64, v11
    v_lshrrev_b32 v12, 6, v11
    v_xor_b32 v12, v12, v4
    v_and_b32 v11, 63, v11
    v_lshl_add_u32 v11, v12, 6, v11
    v_add_u32 v27, v11, v10
    v_mul_u32_u24 v10, 192, v9
    v_add3_u32 v10, v10, v8, 64
    v_add_u32 v29, 98304, v10
    s_lshl_b32 s60, s53, 7
    s_sub_u32 s60, s60, 64
    v_add_u32 v28, s60, v29
    v_mov_b32 v16, 0
    v_lshlrev_b32 v17, 4, v1
    s_waitcnt lgkmcnt(0)
    s_mov_b32 s4, s44
    s_and_b32 s5, s45, 0xffff
    s_mov_b32 s6, 268435456
    s_mov_b32 s7, 0x00020000
    v_mov_b32 v80, 0
    v_mov_b32 v81, 0
    v_mov_b32 v82, 0
    v_mov_b32 v83, 0
    v_mov_b32 v84, 0
    v_mov_b32 v85, 0
    v_mov_b32 v86, 0
    v_mov_b32 v87, 0
    s_cmp_eq_u32 s3, 3
    s_cbranch_scc1 parallel_sum__softmax_full_mha__mixer_channel_mlp__prompt_kernel_s3
    s_cmp_lg_u32 s3, 0
    s_cbranch_scc1 parallel_sum__softmax_full_mha__mixer_channel_mlp__prompt_kernel_s12
    s_mov_b32 s8, s24
    s_and_b32 s9, s25, 0xffff
    s_mov_b32 s10, 2621440
    s_mov_b32 s11, 0x00020000
    v_lshrrev_b32 v12, 3, v1
    v_mul_u32_u24 v4, 1280, v12
    v_and_b32 v5, 7, v1
    v_lshl_add_u32 v4, v5, 4, v4
    s_lshl_b32 s60, s46, 4
    s_add_u32 s60, s60, s47
    s_mul_i32 s61, s60, 10240
    buffer_load_dwordx4 v[32:35], v4, s[8:11], s61 offen offset:0
    buffer_load_dwordx4 v[36:39], v4, s[8:11], s61 offen offset:128
    buffer_load_dwordx4 v[40:43], v4, s[8:11], s61 offen offset:256
    buffer_load_dwordx4 v[44:47], v4, s[8:11], s61 offen offset:384
    buffer_load_dwordx4 v[48:51], v4, s[8:11], s61 offen offset:512
    buffer_load_dwordx4 v[52:55], v4, s[8:11], s61 offen offset:640
    buffer_load_dwordx4 v[56:59], v4, s[8:11], s61 offen offset:768
    buffer_load_dwordx4 v[60:63], v4, s[8:11], s61 offen offset:896
    buffer_load_dwordx4 v[64:67], v4, s[8:11], s61 offen offset:1024
    buffer_load_dwordx4 v[68:71], v4, s[8:11], s61 offen offset:1152
    s_waitcnt vmcnt(9)
    v_lshlrev_b32 v4, 16, v32
    v_and_b32 v5, 0xffff0000, v32
    v_add_f32 v80, v80, v4
    v_add_f32 v81, v81, v5
    v_fmac_f32 v82, v4, v4
    v_fmac_f32 v83, v5, v5
    v_lshlrev_b32 v4, 16, v33
    v_and_b32 v5, 0xffff0000, v33
    v_add_f32 v80, v80, v4
    v_add_f32 v81, v81, v5
    v_fmac_f32 v82, v4, v4
    v_fmac_f32 v83, v5, v5
    v_lshlrev_b32 v4, 16, v34
    v_and_b32 v5, 0xffff0000, v34
    v_add_f32 v80, v80, v4
    v_add_f32 v81, v81, v5
    v_fmac_f32 v82, v4, v4
    v_fmac_f32 v83, v5, v5
    v_lshlrev_b32 v4, 16, v35
    v_and_b32 v5, 0xffff0000, v35
    v_add_f32 v80, v80, v4
    v_add_f32 v81, v81, v5
    v_fmac_f32 v82, v4, v4
    v_fmac_f32 v83, v5, v5
    s_waitcnt vmcnt(8)
    v_lshlrev_b32 v4, 16, v36
    v_and_b32 v5, 0xffff0000, v36
    v_add_f32 v80, v80, v4
    v_add_f32 v81, v81, v5
    v_fmac_f32 v82, v4, v4
    v_fmac_f32 v83, v5, v5
    v_lshlrev_b32 v4, 16, v37
    v_and_b32 v5, 0xffff0000, v37
    v_add_f32 v80, v80, v4
    v_add_f32 v81, v81, v5
    v_fmac_f32 v82, v4, v4
    v_fmac_f32 v83, v5, v5
    v_lshlrev_b32 v4, 16, v38
    v_and_b32 v5, 0xffff0000, v38
    v_add_f32 v80, v80, v4
    v_add_f32 v81, v81, v5
    v_fmac_f32 v82, v4, v4
    v_fmac_f32 v83, v5, v5
    v_lshlrev_b32 v4, 16, v39
    v_and_b32 v5, 0xffff0000, v39
    v_add_f32 v80, v80, v4
    v_add_f32 v81, v81, v5
    v_fmac_f32 v82, v4, v4
    v_fmac_f32 v83, v5, v5
    s_waitcnt vmcnt(7)
    v_lshlrev_b32 v4, 16, v40
    v_and_b32 v5, 0xffff0000, v40
    v_add_f32 v80, v80, v4
    v_add_f32 v81, v81, v5
    v_fmac_f32 v82, v4, v4
    v_fmac_f32 v83, v5, v5
    v_lshlrev_b32 v4, 16, v41
    v_and_b32 v5, 0xffff0000, v41
    v_add_f32 v80, v80, v4
    v_add_f32 v81, v81, v5
    v_fmac_f32 v82, v4, v4
    v_fmac_f32 v83, v5, v5
    v_lshlrev_b32 v4, 16, v42
    v_and_b32 v5, 0xffff0000, v42
    v_add_f32 v80, v80, v4
    v_add_f32 v81, v81, v5
    v_fmac_f32 v82, v4, v4
    v_fmac_f32 v83, v5, v5
    v_lshlrev_b32 v4, 16, v43
    v_and_b32 v5, 0xffff0000, v43
    v_add_f32 v80, v80, v4
    v_add_f32 v81, v81, v5
    v_fmac_f32 v82, v4, v4
    v_fmac_f32 v83, v5, v5
    s_waitcnt vmcnt(6)
    v_lshlrev_b32 v4, 16, v44
    v_and_b32 v5, 0xffff0000, v44
    v_add_f32 v80, v80, v4
    v_add_f32 v81, v81, v5
    v_fmac_f32 v82, v4, v4
    v_fmac_f32 v83, v5, v5
    v_lshlrev_b32 v4, 16, v45
    v_and_b32 v5, 0xffff0000, v45
    v_add_f32 v80, v80, v4
    v_add_f32 v81, v81, v5
    v_fmac_f32 v82, v4, v4
    v_fmac_f32 v83, v5, v5
    v_lshlrev_b32 v4, 16, v46
    v_and_b32 v5, 0xffff0000, v46
    v_add_f32 v80, v80, v4
    v_add_f32 v81, v81, v5
    v_fmac_f32 v82, v4, v4
    v_fmac_f32 v83, v5, v5
    v_lshlrev_b32 v4, 16, v47
    v_and_b32 v5, 0xffff0000, v47
    v_add_f32 v80, v80, v4
    v_add_f32 v81, v81, v5
    v_fmac_f32 v82, v4, v4
    v_fmac_f32 v83, v5, v5
    s_waitcnt vmcnt(5)
    v_lshlrev_b32 v4, 16, v48
    v_and_b32 v5, 0xffff0000, v48
    v_add_f32 v80, v80, v4
    v_add_f32 v81, v81, v5
    v_fmac_f32 v82, v4, v4
    v_fmac_f32 v83, v5, v5
    v_lshlrev_b32 v4, 16, v49
    v_and_b32 v5, 0xffff0000, v49
    v_add_f32 v80, v80, v4
    v_add_f32 v81, v81, v5
    v_fmac_f32 v82, v4, v4
    v_fmac_f32 v83, v5, v5
    v_lshlrev_b32 v4, 16, v50
    v_and_b32 v5, 0xffff0000, v50
    v_add_f32 v80, v80, v4
    v_add_f32 v81, v81, v5
    v_fmac_f32 v82, v4, v4
    v_fmac_f32 v83, v5, v5
    v_lshlrev_b32 v4, 16, v51
    v_and_b32 v5, 0xffff0000, v51
    v_add_f32 v80, v80, v4
    v_add_f32 v81, v81, v5
    v_fmac_f32 v82, v4, v4
    v_fmac_f32 v83, v5, v5
    s_waitcnt vmcnt(4)
    v_lshlrev_b32 v4, 16, v52
    v_and_b32 v5, 0xffff0000, v52
    v_add_f32 v80, v80, v4
    v_add_f32 v81, v81, v5
    v_fmac_f32 v82, v4, v4
    v_fmac_f32 v83, v5, v5
    v_lshlrev_b32 v4, 16, v53
    v_and_b32 v5, 0xffff0000, v53
    v_add_f32 v80, v80, v4
    v_add_f32 v81, v81, v5
    v_fmac_f32 v82, v4, v4
    v_fmac_f32 v83, v5, v5
    v_lshlrev_b32 v4, 16, v54
    v_and_b32 v5, 0xffff0000, v54
    v_add_f32 v80, v80, v4
    v_add_f32 v81, v81, v5
    v_fmac_f32 v82, v4, v4
    v_fmac_f32 v83, v5, v5
    v_lshlrev_b32 v4, 16, v55
    v_and_b32 v5, 0xffff0000, v55
    v_add_f32 v80, v80, v4
    v_add_f32 v81, v81, v5
    v_fmac_f32 v82, v4, v4
    v_fmac_f32 v83, v5, v5
    s_waitcnt vmcnt(3)
    v_lshlrev_b32 v4, 16, v56
    v_and_b32 v5, 0xffff0000, v56
    v_add_f32 v80, v80, v4
    v_add_f32 v81, v81, v5
    v_fmac_f32 v82, v4, v4
    v_fmac_f32 v83, v5, v5
    v_lshlrev_b32 v4, 16, v57
    v_and_b32 v5, 0xffff0000, v57
    v_add_f32 v80, v80, v4
    v_add_f32 v81, v81, v5
    v_fmac_f32 v82, v4, v4
    v_fmac_f32 v83, v5, v5
    v_lshlrev_b32 v4, 16, v58
    v_and_b32 v5, 0xffff0000, v58
    v_add_f32 v80, v80, v4
    v_add_f32 v81, v81, v5
    v_fmac_f32 v82, v4, v4
    v_fmac_f32 v83, v5, v5
    v_lshlrev_b32 v4, 16, v59
    v_and_b32 v5, 0xffff0000, v59
    v_add_f32 v80, v80, v4
    v_add_f32 v81, v81, v5
    v_fmac_f32 v82, v4, v4
    v_fmac_f32 v83, v5, v5
    s_waitcnt vmcnt(2)
    v_lshlrev_b32 v4, 16, v60
    v_and_b32 v5, 0xffff0000, v60
    v_add_f32 v80, v80, v4
    v_add_f32 v81, v81, v5
    v_fmac_f32 v82, v4, v4
    v_fmac_f32 v83, v5, v5
    v_lshlrev_b32 v4, 16, v61
    v_and_b32 v5, 0xffff0000, v61
    v_add_f32 v80, v80, v4
    v_add_f32 v81, v81, v5
    v_fmac_f32 v82, v4, v4
    v_fmac_f32 v83, v5, v5
    v_lshlrev_b32 v4, 16, v62
    v_and_b32 v5, 0xffff0000, v62
    v_add_f32 v80, v80, v4
    v_add_f32 v81, v81, v5
    v_fmac_f32 v82, v4, v4
    v_fmac_f32 v83, v5, v5
    v_lshlrev_b32 v4, 16, v63
    v_and_b32 v5, 0xffff0000, v63
    v_add_f32 v80, v80, v4
    v_add_f32 v81, v81, v5
    v_fmac_f32 v82, v4, v4
    v_fmac_f32 v83, v5, v5
    s_waitcnt vmcnt(1)
    v_lshlrev_b32 v4, 16, v64
    v_and_b32 v5, 0xffff0000, v64
    v_add_f32 v80, v80, v4
    v_add_f32 v81, v81, v5
    v_fmac_f32 v82, v4, v4
    v_fmac_f32 v83, v5, v5
    v_lshlrev_b32 v4, 16, v65
    v_and_b32 v5, 0xffff0000, v65
    v_add_f32 v80, v80, v4
    v_add_f32 v81, v81, v5
    v_fmac_f32 v82, v4, v4
    v_fmac_f32 v83, v5, v5
    v_lshlrev_b32 v4, 16, v66
    v_and_b32 v5, 0xffff0000, v66
    v_add_f32 v80, v80, v4
    v_add_f32 v81, v81, v5
    v_fmac_f32 v82, v4, v4
    v_fmac_f32 v83, v5, v5
    v_lshlrev_b32 v4, 16, v67
    v_and_b32 v5, 0xffff0000, v67
    v_add_f32 v80, v80, v4
    v_add_f32 v81, v81, v5
    v_fmac_f32 v82, v4, v4
    v_fmac_f32 v83, v5, v5
    s_waitcnt vmcnt(0)
    v_lshlrev_b32 v4, 16, v68
    v_and_b32 v5, 0xffff0000, v68
    v_add_f32 v80, v80, v4
    v_add_f32 v81, v81, v5
    v_fmac_f32 v82, v4, v4
    v_fmac_f32 v83, v5, v5
    v_lshlrev_b32 v4, 16, v69
    v_and_b32 v5, 0xffff0000, v69
    v_add_f32 v80, v80, v4
    v_add_f32 v81, v81, v5
    v_fmac_f32 v82, v4, v4
    v_fmac_f32 v83, v5, v5
    v_lshlrev_b32 v4, 16, v70
    v_and_b32 v5, 0xffff0000, v70
    v_add_f32 v80, v80, v4
    v_add_f32 v81, v81, v5
    v_fmac_f32 v82, v4, v4
    v_fmac_f32 v83, v5, v5
    v_lshlrev_b32 v4, 16, v71
    v_and_b32 v5, 0xffff0000, v71
    v_add_f32 v80, v80, v4
    v_add_f32 v81, v81, v5
    v_fmac_f32 v82, v4, v4
    v_fmac_f32 v83, v5, v5
    v_add_f32 v80, v80, v81
    v_add_f32 v82, v82, v83
    s_nop 1
    v_add_f32_dpp v4, v80, v80 quad_perm:[1,0,3,2] row_mask:0xf bank_mask:0xf
    v_add_f32_dpp v5, v82, v82 quad_perm:[1,0,3,2] row_mask:0xf bank_mask:0xf
    v_mov_b32 v80, v4
    v_mov_b32 v82, v5
    s_nop 1
    v_add_f32_dpp v4, v80, v80 quad_perm:[2,3,0,1] row_mask:0xf bank_mask:0xf
    v_add_f32_dpp v5, v82, v82 quad_perm:[2,3,0,1] row_mask:0xf bank_mask:0xf
    v_mov_b32 v80, v4
    v_mov_b32 v82, v5
    s_nop 1
    v_add_f32_dpp v4, v80, v80 row_half_mirror row_mask:0xf bank_mask:0xf
    v_add_f32_dpp v5, v82, v82 row_half_mirror row_mask:0xf bank_mask:0xf
    v_mov_b32 v80, v4
    v_mov_b32 v82, v5
    s_mov_b32 s60, 0x3acccccd
    s_mov_b32 s61, 0x3727c5ac
    v_mul_f32 v4, s60, v80
    v_mul_f32 v5, s60, v82
    v_fma_f32 v5, -v4, v4, v5
    v_max_f32 v5, 0, v5
    v_cvt_pk_bf16_f32 v6, v4, v4
    v_lshlrev_b32 v6, 16, v6
    v_cvt_pk_bf16_f32 v11, v5, v5
    v_lshlrev_b32 v11, 16, v11
    v_add_f32 v11, s61, v11
    v_cvt_pk_bf16_f32 v11, v11, v11
    v_lshlrev_b32 v11, 16, v11
    v_sqrt_f32 v11, v11
    s_nop 0
    v_cvt_pk_bf16_f32 v7, v11, v11
    v_lshlrev_b32 v7, 16, v7
    v_rcp_f32 v8, v7
    v_sub_f32 v84, 0, v6
    v_mov_b32 v85, v8
    v_sub_f32 v11, v4, v6
    v_mul_f32 v11, v11, v8
    v_cvt_pk_bf16_f32 v9, v11, v11
    v_lshlrev_b32 v9, 16, v9
    v_mul_f32 v11, v5, v8
    v_mul_f32 v11, v11, v8
    v_cvt_pk_bf16_f32 v11, v11, v11
    v_lshlrev_b32 v11, 16, v11
    v_add_f32 v11, s61, v11
    v_cvt_pk_bf16_f32 v11, v11, v11
    v_lshlrev_b32 v11, 16, v11
    v_sqrt_f32 v11, v11
    s_nop 0
    v_cvt_pk_bf16_f32 v10, v11, v11
    v_lshlrev_b32 v10, 16, v10
    v_mul_f32 v11, v7, v10
    v_rcp_f32 v86, v11
    v_fma_f32 v11, v9, v7, v6
    v_mul_f32 v87, v11, v86
    v_sub_f32 v87, 0, v87
    v_lshlrev_b32 v12, 4, v12
    v_add_u32 v12, 154176, v12
    ds_write_b128 v12, v[84:87]
    s_branch parallel_sum__softmax_full_mha__mixer_channel_mlp__prompt_kernel_sj
parallel_sum__softmax_full_mha__mixer_channel_mlp__prompt_kernel_s12:
    s_cmp_eq_u32 s3, 1
    s_cbranch_scc1 parallel_sum__softmax_full_mha__mixer_channel_mlp__prompt_kernel_sq
    s_mov_b32 s8, s32
    s_and_b32 s9, s33, 0xffff
    s_mov_b32 s10, 1966080
    s_mov_b32 s11, 0x00020000
    s_movk_i32 s62, 3072
    s_mul_i32 s60, s47, 192
    s_branch parallel_sum__softmax_full_mha__mixer_channel_mlp__prompt_kernel_sq2
parallel_sum__softmax_full_mha__mixer_channel_mlp__prompt_kernel_sq:
    s_mov_b32 s8, s26
    s_and_b32 s9, s27, 0xffff
    s_mov_b32 s10, 2457600
    s_mov_b32 s11, 0x00020000
    s_movk_i32 s62, 3840
    s_mul_i32 s60, s47, 240
parallel_sum__softmax_full_mha__mixer_channel_mlp__prompt_kernel_sq2:
    s_mul_i32 s61, s46, 40
    s_mul_i32 s61, s61, s62
    s_add_u32 s61, s61, s60
    v_lshrrev_b32 v12, 4, v1
    v_mul_lo_u32 v4, v12, s62
    v_and_b32 v13, 15, v1
    v_lshl_add_u32 v4, v13, 4, v4
    s_lshl_b32 s62, s62, 2
    buffer_load_dwordx4 v[32:35], v4, s[8:11], s61 offen
    s_add_u32 s61, s61, s62
    buffer_load_dwordx4 v[36:39], v4, s[8:11], s61 offen
    s_add_u32 s61, s61, s62
    buffer_load_dwordx4 v[40:43], v4, s[8:11], s61 offen
    s_add_u32 s61, s61, s62
    buffer_load_dwordx4 v[44:47], v4, s[8:11], s61 offen
    s_add_u32 s61, s61, s62
    buffer_load_dwordx4 v[48:51], v4, s[8:11], s61 offen
    s_add_u32 s61, s61, s62
    buffer_load_dwordx4 v[52:55], v4, s[8:11], s61 offen
    s_add_u32 s61, s61, s62
    buffer_load_dwordx4 v[56:59], v4, s[8:11], s61 offen
    s_add_u32 s61, s61, s62
    buffer_load_dwordx4 v[60:63], v4, s[8:11], s61 offen
    s_add_u32 s61, s61, s62
    buffer_load_dwordx4 v[64:67], v4, s[8:11], s61 offen
    s_add_u32 s61, s61, s62
    buffer_load_dwordx4 v[68:71], v4, s[8:11], s61 offen
    s_waitcnt vmcnt(9)
    v_lshlrev_b32 v4, 16, v32
    v_and_b32 v5, 0xffff0000, v32
    v_add_f32 v80, v80, v4
    v_add_f32 v81, v81, v5
    v_lshlrev_b32 v4, 16, v33
    v_and_b32 v5, 0xffff0000, v33
    v_add_f32 v82, v82, v4
    v_add_f32 v83, v83, v5
    v_lshlrev_b32 v4, 16, v34
    v_and_b32 v5, 0xffff0000, v34
    v_add_f32 v84, v84, v4
    v_add_f32 v85, v85, v5
    v_lshlrev_b32 v4, 16, v35
    v_and_b32 v5, 0xffff0000, v35
    v_add_f32 v86, v86, v4
    v_add_f32 v87, v87, v5
    s_waitcnt vmcnt(8)
    v_lshlrev_b32 v4, 16, v36
    v_and_b32 v5, 0xffff0000, v36
    v_add_f32 v80, v80, v4
    v_add_f32 v81, v81, v5
    v_lshlrev_b32 v4, 16, v37
    v_and_b32 v5, 0xffff0000, v37
    v_add_f32 v82, v82, v4
    v_add_f32 v83, v83, v5
    v_lshlrev_b32 v4, 16, v38
    v_and_b32 v5, 0xffff0000, v38
    v_add_f32 v84, v84, v4
    v_add_f32 v85, v85, v5
    v_lshlrev_b32 v4, 16, v39
    v_and_b32 v5, 0xffff0000, v39
    v_add_f32 v86, v86, v4
    v_add_f32 v87, v87, v5
    s_waitcnt vmcnt(7)
    v_lshlrev_b32 v4, 16, v40
    v_and_b32 v5, 0xffff0000, v40
    v_add_f32 v80, v80, v4
    v_add_f32 v81, v81, v5
    v_lshlrev_b32 v4, 16, v41
    v_and_b32 v5, 0xffff0000, v41
    v_add_f32 v82, v82, v4
    v_add_f32 v83, v83, v5
    v_lshlrev_b32 v4, 16, v42
    v_and_b32 v5, 0xffff0000, v42
    v_add_f32 v84, v84, v4
    v_add_f32 v85, v85, v5
    v_lshlrev_b32 v4, 16, v43
    v_and_b32 v5, 0xffff0000, v43
    v_add_f32 v86, v86, v4
    v_add_f32 v87, v87, v5
    s_waitcnt vmcnt(6)
    v_lshlrev_b32 v4, 16, v44
    v_and_b32 v5, 0xffff0000, v44
    v_add_f32 v80, v80, v4
    v_add_f32 v81, v81, v5
    v_lshlrev_b32 v4, 16, v45
    v_and_b32 v5, 0xffff0000, v45
    v_add_f32 v82, v82, v4
    v_add_f32 v83, v83, v5
    v_lshlrev_b32 v4, 16, v46
    v_and_b32 v5, 0xffff0000, v46
    v_add_f32 v84, v84, v4
    v_add_f32 v85, v85, v5
    v_lshlrev_b32 v4, 16, v47
    v_and_b32 v5, 0xffff0000, v47
    v_add_f32 v86, v86, v4
    v_add_f32 v87, v87, v5
    s_waitcnt vmcnt(5)
    v_lshlrev_b32 v4, 16, v48
    v_and_b32 v5, 0xffff0000, v48
    v_add_f32 v80, v80, v4
    v_add_f32 v81, v81, v5
    v_lshlrev_b32 v4, 16, v49
    v_and_b32 v5, 0xffff0000, v49
    v_add_f32 v82, v82, v4
    v_add_f32 v83, v83, v5
    v_lshlrev_b32 v4, 16, v50
    v_and_b32 v5, 0xffff0000, v50
    v_add_f32 v84, v84, v4
    v_add_f32 v85, v85, v5
    v_lshlrev_b32 v4, 16, v51
    v_and_b32 v5, 0xffff0000, v51
    v_add_f32 v86, v86, v4
    v_add_f32 v87, v87, v5
    s_waitcnt vmcnt(4)
    v_lshlrev_b32 v4, 16, v52
    v_and_b32 v5, 0xffff0000, v52
    v_add_f32 v80, v80, v4
    v_add_f32 v81, v81, v5
    v_lshlrev_b32 v4, 16, v53
    v_and_b32 v5, 0xffff0000, v53
    v_add_f32 v82, v82, v4
    v_add_f32 v83, v83, v5
    v_lshlrev_b32 v4, 16, v54
    v_and_b32 v5, 0xffff0000, v54
    v_add_f32 v84, v84, v4
    v_add_f32 v85, v85, v5
    v_lshlrev_b32 v4, 16, v55
    v_and_b32 v5, 0xffff0000, v55
    v_add_f32 v86, v86, v4
    v_add_f32 v87, v87, v5
    s_waitcnt vmcnt(3)
    v_lshlrev_b32 v4, 16, v56
    v_and_b32 v5, 0xffff0000, v56
    v_add_f32 v80, v80, v4
    v_add_f32 v81, v81, v5
    v_lshlrev_b32 v4, 16, v57
    v_and_b32 v5, 0xffff0000, v57
    v_add_f32 v82, v82, v4
    v_add_f32 v83, v83, v5
    v_lshlrev_b32 v4, 16, v58
    v_and_b32 v5, 0xffff0000, v58
    v_add_f32 v84, v84, v4
    v_add_f32 v85, v85, v5
    v_lshlrev_b32 v4, 16, v59
    v_and_b32 v5, 0xffff0000, v59
    v_add_f32 v86, v86, v4
    v_add_f32 v87, v87, v5
    s_waitcnt vmcnt(2)
    v_lshlrev_b32 v4, 16, v60
    v_and_b32 v5, 0xffff0000, v60
    v_add_f32 v80, v80, v4
    v_add_f32 v81, v81, v5
    v_lshlrev_b32 v4, 16, v61
    v_and_b32 v5, 0xffff0000, v61
    v_add_f32 v82, v82, v4
    v_add_f32 v83, v83, v5
    v_lshlrev_b32 v4, 16, v62
    v_and_b32 v5, 0xffff0000, v62
    v_add_f32 v84, v84, v4
    v_add_f32 v85, v85, v5
    v_lshlrev_b32 v4, 16, v63
    v_and_b32 v5, 0xffff0000, v63
    v_add_f32 v86, v86, v4
    v_add_f32 v87, v87, v5
    s_waitcnt vmcnt(1)
    v_lshlrev_b32 v4, 16, v64
    v_and_b32 v5, 0xffff0000, v64
    v_add_f32 v80, v80, v4
    v_add_f32 v81, v81, v5
    v_lshlrev_b32 v4, 16, v65
    v_and_b32 v5, 0xffff0000, v65
    v_add_f32 v82, v82, v4
    v_add_f32 v83, v83, v5
    v_lshlrev_b32 v4, 16, v66
    v_and_b32 v5, 0xffff0000, v66
    v_add_f32 v84, v84, v4
    v_add_f32 v85, v85, v5
    v_lshlrev_b32 v4, 16, v67
    v_and_b32 v5, 0xffff0000, v67
    v_add_f32 v86, v86, v4
    v_add_f32 v87, v87, v5
    s_waitcnt vmcnt(0)
    v_lshlrev_b32 v4, 16, v68
    v_and_b32 v5, 0xffff0000, v68
    v_add_f32 v80, v80, v4
    v_add_f32 v81, v81, v5
    v_lshlrev_b32 v4, 16, v69
    v_and_b32 v5, 0xffff0000, v69
    v_add_f32 v82, v82, v4
    v_add_f32 v83, v83, v5
    v_lshlrev_b32 v4, 16, v70
    v_and_b32 v5, 0xffff0000, v70
    v_add_f32 v84, v84, v4
    v_add_f32 v85, v85, v5
    v_lshlrev_b32 v4, 16, v71
    v_and_b32 v5, 0xffff0000, v71
    v_add_f32 v86, v86, v4
    v_add_f32 v87, v87, v5
    s_lshl_b32 s60, s3, 11
    s_add_u32 s60, s60, 152256
    v_lshl_add_u32 v12, v1, 5, s60
    ds_write_b128 v12, v[80:83]
    ds_write_b128 v12, v[84:87] offset:16
    s_branch parallel_sum__softmax_full_mha__mixer_channel_mlp__prompt_kernel_sj
parallel_sum__softmax_full_mha__mixer_channel_mlp__prompt_kernel_s3:
    s_mov_b32 s8, s34
    s_and_b32 s9, s35, 0xffff
    s_mov_b32 s10, 3072
    s_mov_b32 s11, 0x00020000
    s_mul_i32 s60, s47, 192
    v_lshlrev_b32 v4, 2, v1
    buffer_load_dword v32, v4, s[8:11], s60 offen
    v_lshlrev_b32 v4, 3, v1
    v_add_u32 v4, 138240, v4
    v_mov_b32 v5, 138768
    ds_write_b32 v5, v16
    s_waitcnt vmcnt(0)
    v_lshlrev_b32 v80, 16, v32
    v_and_b32 v81, 0xffff0000, v32
    ds_write_b64 v4, v[80:81]
parallel_sum__softmax_full_mha__mixer_channel_mlp__prompt_kernel_sj:
    s_waitcnt lgkmcnt(0)
    v_mov_b32 v32, 0
    v_mov_b32 v33, 0
    v_mov_b32 v34, 0
    v_mov_b32 v35, 0
    v_mov_b32 v36, 0
    v_mov_b32 v37, 0
    v_mov_b32 v38, 0
    v_mov_b32 v39, 0
    v_mov_b32 v40, 0
    v_mov_b32 v41, 0
    v_mov_b32 v42, 0
    v_mov_b32 v43, 0
    v_mov_b32 v44, 0
    v_mov_b32 v45, 0
    v_mov_b32 v46, 0
    v_mov_b32 v47, 0
    v_mov_b32 v48, 0
    v_mov_b32 v49, 0
    v_mov_b32 v50, 0
    v_mov_b32 v51, 0
    v_mov_b32 v52, 0
    v_mov_b32 v53, 0
    v_mov_b32 v54, 0
    v_mov_b32 v55, 0
    v_mov_b32 v56, 0
    v_mov_b32 v57, 0
    v_mov_b32 v58, 0
    v_mov_b32 v59, 0
    v_mov_b32 v60, 0
    v_mov_b32 v61, 0
    v_mov_b32 v62, 0
    v_mov_b32 v63, 0
    v_mov_b32 v64, 0
    v_mov_b32 v65, 0
    v_mov_b32 v66, 0
    v_mov_b32 v67, 0
    v_mov_b32 v68, 0
    v_mov_b32 v69, 0
    v_mov_b32 v70, 0
    v_mov_b32 v71, 0
    v_mov_b32 v72, 0
    v_mov_b32 v73, 0
    v_mov_b32 v74, 0
    v_mov_b32 v75, 0
    v_mov_b32 v76, 0
    v_mov_b32 v77, 0
    v_mov_b32 v78, 0
    v_mov_b32 v79, 0
    v_mov_b32 v80, 0
    v_mov_b32 v81, 0
    v_mov_b32 v82, 0
    v_mov_b32 v83, 0
    v_mov_b32 v84, 0
    v_mov_b32 v85, 0
    v_mov_b32 v86, 0
    v_mov_b32 v87, 0
    v_mov_b32 v88, 0
    v_mov_b32 v89, 0
    v_mov_b32 v90, 0
    v_mov_b32 v91, 0
    v_mov_b32 v92, 0
    v_mov_b32 v93, 0
    v_mov_b32 v94, 0
    v_mov_b32 v95, 0
    v_mov_b32 v96, 0
    v_mov_b32 v97, 0
    v_mov_b32 v98, 0
    v_mov_b32 v99, 0
    v_mov_b32 v100, 0
    v_mov_b32 v101, 0
    v_mov_b32 v102, 0
    v_mov_b32 v103, 0
    v_mov_b32 v104, 0
    v_mov_b32 v105, 0
    v_mov_b32 v106, 0
    v_mov_b32 v107, 0
    v_mov_b32 v108, 0
    v_mov_b32 v109, 0
    v_mov_b32 v110, 0
    v_mov_b32 v111, 0
    v_mov_b32 v112, 0
    v_mov_b32 v113, 0
    v_mov_b32 v114, 0
    v_mov_b32 v115, 0
    v_mov_b32 v116, 0
    v_mov_b32 v117, 0
    v_mov_b32 v118, 0
    v_mov_b32 v119, 0
    v_mov_b32 v120, 0
    v_mov_b32 v121, 0
    v_mov_b32 v122, 0
    v_mov_b32 v123, 0
    v_mov_b32 v124, 0
    v_mov_b32 v125, 0
    v_mov_b32 v126, 0
    v_mov_b32 v127, 0
    v_mov_b32 v128, 0
    v_mov_b32 v129, 0
    v_mov_b32 v130, 0
    v_mov_b32 v131, 0
    v_mov_b32 v132, 0
    v_mov_b32 v133, 0
    v_mov_b32 v134, 0
    v_mov_b32 v135, 0
    v_mov_b32 v136, 0
    v_mov_b32 v137, 0
    v_mov_b32 v138, 0
    v_mov_b32 v139, 0
    v_mov_b32 v140, 0
    v_mov_b32 v141, 0
    v_mov_b32 v142, 0
    v_mov_b32 v143, 0
    s_movk_i32 s63, 16384
    s_movk_i32 s65, 12288
    s_mov_b32 s60, 0
    s_mov_b32 s61, 0
    s_mov_b32 s69, 0
    s_barrier
    ds_read_b128 v[144:147], v18
    ds_read_b128 v[148:151], v22
    ds_read_b64_tr_b16 v[160:161], v26 offset:0
    ds_read_b64_tr_b16 v[162:163], v26 offset:1024
    ds_read_b64_tr_b16 v[164:165], v27 offset:0
    ds_read_b64_tr_b16 v[166:167], v27 offset:1024
    ds_read_b64_tr_b16 v[168:169], v28 offset:0
    ds_read_b64_tr_b16 v[170:171], v28 offset:768
    ds_read_b64_tr_b16 v[172:173], v29 offset:0
    ds_read_b64_tr_b16 v[174:175], v29 offset:768
    s_waitcnt lgkmcnt(0)
.p2align 6
parallel_sum__softmax_full_mha__mixer_channel_mlp__prompt_kernel_a1:
    s_waitcnt lgkmcnt(7)
    v_mfma_f32_32x32x16_bf16 v[32:47], v[160:163], v[144:147], v[32:47]
    ds_read_b128 v[152:155], v19
    ds_read_b64_tr_b16 v[176:177], v26 offset:4096
    s_waitcnt lgkmcnt(8)
    v_mfma_f32_32x32x16_bf16 v[48:63], v[160:163], v[148:151], v[48:63]
    ds_read_b64_tr_b16 v[178:179], v26 offset:5120
    ds_read_b128 v[156:159], v23
    s_waitcnt lgkmcnt(8)
    v_mfma_f32_32x32x16_bf16 v[64:79], v[164:167], v[144:147], v[64:79]
    ds_read_b64_tr_b16 v[180:181], v27 offset:4096
    ds_read_b64_tr_b16 v[182:183], v27 offset:5120
    v_mfma_f32_32x32x16_bf16 v[80:95], v[164:167], v[148:151], v[80:95]
    ds_read_b64_tr_b16 v[184:185], v28 offset:3072
    ds_read_b64_tr_b16 v[186:187], v28 offset:3840
    s_waitcnt lgkmcnt(10)
    v_mfma_f32_32x32x16_bf16 v[96:111], v[168:171], v[144:147], v[96:111]
    ds_read_b64_tr_b16 v[188:189], v29 offset:3072
    ds_read_b64_tr_b16 v[190:191], v29 offset:3840
    v_mfma_f32_32x32x16_bf16 v[112:127], v[168:171], v[148:151], v[112:127]
    s_waitcnt lgkmcnt(10)
    v_mfma_f32_32x32x16_bf16 v[128:143], v[172:175], v[144:147], v[128:143]
    s_waitcnt lgkmcnt(7)
    v_mfma_f32_32x32x16_bf16 v[32:47], v[176:179], v[152:155], v[32:47]
    ds_read_b128 v[144:147], v20
    ds_read_b64_tr_b16 v[160:161], v26 offset:8192
    s_waitcnt lgkmcnt(8)
    v_mfma_f32_32x32x16_bf16 v[48:63], v[176:179], v[156:159], v[48:63]
    ds_read_b64_tr_b16 v[162:163], v26 offset:9216
    ds_read_b128 v[148:151], v24
    s_waitcnt lgkmcnt(8)
    v_mfma_f32_32x32x16_bf16 v[64:79], v[180:183], v[152:155], v[64:79]
    ds_read_b64_tr_b16 v[164:165], v27 offset:8192
    ds_read_b64_tr_b16 v[166:167], v27 offset:9216
    v_mfma_f32_32x32x16_bf16 v[80:95], v[180:183], v[156:159], v[80:95]
    ds_read_b64_tr_b16 v[168:169], v28 offset:6144
    ds_read_b64_tr_b16 v[170:171], v28 offset:6912
    s_waitcnt lgkmcnt(10)
    v_mfma_f32_32x32x16_bf16 v[96:111], v[184:187], v[152:155], v[96:111]
    ds_read_b64_tr_b16 v[172:173], v29 offset:6144
    ds_read_b64_tr_b16 v[174:175], v29 offset:6912
    v_mfma_f32_32x32x16_bf16 v[112:127], v[184:187], v[156:159], v[112:127]
    s_waitcnt lgkmcnt(10)
    v_mfma_f32_32x32x16_bf16 v[128:143], v[188:191], v[152:155], v[128:143]
    s_waitcnt lgkmcnt(7)
    v_mfma_f32_32x32x16_bf16 v[32:47], v[160:163], v[144:147], v[32:47]
    ds_read_b128 v[152:155], v21
    ds_read_b64_tr_b16 v[176:177], v26 offset:12288
    s_waitcnt lgkmcnt(8)
    v_mfma_f32_32x32x16_bf16 v[48:63], v[160:163], v[148:151], v[48:63]
    ds_read_b64_tr_b16 v[178:179], v26 offset:13312
    ds_read_b128 v[156:159], v25
    s_waitcnt lgkmcnt(8)
    v_mfma_f32_32x32x16_bf16 v[64:79], v[164:167], v[144:147], v[64:79]
    ds_read_b64_tr_b16 v[180:181], v27 offset:12288
    ds_read_b64_tr_b16 v[182:183], v27 offset:13312
    v_mfma_f32_32x32x16_bf16 v[80:95], v[164:167], v[148:151], v[80:95]
    ds_read_b64_tr_b16 v[184:185], v28 offset:9216
    ds_read_b64_tr_b16 v[186:187], v28 offset:9984
    s_waitcnt lgkmcnt(10)
    v_mfma_f32_32x32x16_bf16 v[96:111], v[168:171], v[144:147], v[96:111]
    ds_read_b64_tr_b16 v[188:189], v29 offset:9216
    ds_read_b64_tr_b16 v[190:191], v29 offset:9984
    s_add_u32 s61, s61, 1
    s_cmp_eq_u32 s61, 3
    s_cselect_b32 s61, 0, s61
    s_cselect_b32 s62, 0xffff8000, s63
    s_cselect_b32 s64, 0xffffa000, s65
    v_mfma_f32_32x32x16_bf16 v[112:127], v[168:171], v[148:151], v[112:127]
    v_add_u32 v18, s62, v18
    v_add_u32 v19, s62, v19
    v_add_u32 v20, s62, v20
    v_add_u32 v21, s62, v21
    v_add_u32 v22, s62, v22
    v_add_u32 v23, s62, v23
    s_waitcnt lgkmcnt(10)
    v_mfma_f32_32x32x16_bf16 v[128:143], v[172:175], v[144:147], v[128:143]
    v_add_u32 v24, s62, v24
    v_add_u32 v25, s62, v25
    v_add_u32 v26, s62, v26
    v_add_u32 v27, s62, v27
    v_add_u32 v28, s64, v28
    v_add_u32 v29, s64, v29
    s_waitcnt lgkmcnt(0)
    s_cmp_eq_u32 s60, 9
    s_cbranch_scc1 parallel_sum__softmax_full_mha__mixer_channel_mlp__prompt_kernel_a1last_33
    s_barrier
parallel_sum__softmax_full_mha__mixer_channel_mlp__prompt_kernel_a1last_33:
    v_mfma_f32_32x32x16_bf16 v[32:47], v[176:179], v[152:155], v[32:47]
    ds_read_b128 v[144:147], v18
    ds_read_b64_tr_b16 v[160:161], v26 offset:0
    v_mfma_f32_32x32x16_bf16 v[48:63], v[176:179], v[156:159], v[48:63]
    ds_read_b64_tr_b16 v[162:163], v26 offset:1024
    ds_read_b128 v[148:151], v22
    v_mfma_f32_32x32x16_bf16 v[64:79], v[180:183], v[152:155], v[64:79]
    ds_read_b64_tr_b16 v[164:165], v27 offset:0
    ds_read_b64_tr_b16 v[166:167], v27 offset:1024
    v_mfma_f32_32x32x16_bf16 v[80:95], v[180:183], v[156:159], v[80:95]
    ds_read_b64_tr_b16 v[168:169], v28 offset:0
    ds_read_b64_tr_b16 v[170:171], v28 offset:768
    v_mfma_f32_32x32x16_bf16 v[96:111], v[184:187], v[152:155], v[96:111]
    ds_read_b64_tr_b16 v[172:173], v29 offset:0
    ds_read_b64_tr_b16 v[174:175], v29 offset:768
    v_mfma_f32_32x32x16_bf16 v[112:127], v[184:187], v[156:159], v[112:127]
    v_mfma_f32_32x32x16_bf16 v[128:143], v[188:191], v[152:155], v[128:143]
    s_add_u32 s60, s60, 1
    s_cmp_lt_u32 s60, 10
    s_cbranch_scc1 parallel_sum__softmax_full_mha__mixer_channel_mlp__prompt_kernel_a1
    s_waitcnt vmcnt(0) lgkmcnt(0)
    s_lshl_b32 s60, s52, 10
    s_lshl_b32 s61, s53, 9
    s_add_u32 s60, s60, s61
    s_add_u32 s60, s60, 135168
    v_lshl_add_u32 v4, v2, 4, s60
    v_xor_b32 v13, 0x200, v4
    s_mul_i32 s60, s53, 240
    s_add_u32 s60, s60, 137216
    v_lshl_add_u32 v5, v3, 4, s60
    s_mul_i32 s54, s47, 6
    s_mul_i32 s60, s53, 3
    s_add_u32 s54, s54, s60
    s_mov_b32 s60, 0x3ea52b5c
    s_add_u32 s61, s54, 0
    s_cmp_lt_u32 s61, 32
    s_cselect_b32 s62, s60, 1.0
    s_add_u32 s61, s54, 1
    s_cmp_lt_u32 s61, 32
    s_cselect_b32 s63, s60, 1.0
    s_add_u32 s61, s54, 2
    s_cmp_lt_u32 s61, 32
    s_cselect_b32 s64, s60, 1.0
    s_mul_i32 s60, s3, 12288
    s_mul_i32 s61, s53, 1536
    v_mul_u32_u24 v6, 48, v2
    v_add_u32 v6, s60, v6
    v_mul_u32_u24 v7, 3040, v3
    v_add_u32 v8, s61, v6
    v_subrev_u32 v6, s61, v6
    v_add_u32 v6, 1536, v6
    v_lshl_add_u32 v30, v3, 3, v8
    v_add_u32 v31, v7, v8
    v_lshl_add_u32 v11, v3, 3, v6
    v_add_u32 v12, v7, v6
    v_mul_u32_u24 v6, 48, v1
    v_add_u32 v6, s60, v6
    v_lshl_add_u32 v7, v1, 4, s60
    v_bfe_u32 v9, v1, 2, 2
    v_lshl_add_u32 v9, v3, 3, v9
    v_mul_u32_u24 v9, 48, v9
    v_bfe_u32 v10, v1, 4, 1
    v_lshl_add_u32 v9, v10, 5, v9
    v_and_b32 v10, 3, v1
    v_lshl_add_u32 v9, v10, 3, v9
    v_add_u32 v9, s60, v9
    s_lshl_b32 s55, s46, 1
    s_add_u32 s55, s55, s52
    v_cmp_eq_u32 vcc, 1, v3
    v_cmp_gt_u32 s[66:67], 21, v2
    v_mov_b32 v18, 0x3f803f80
    v_mov_b32 v19, 0x3f80
    v_mov_b32 v10, 138752
    s_barrier
    ds_read_b128 v[144:147], v4
    ds_read_b128 v[148:151], v13
    ds_read_b128 v[160:163], v5 offset:0
    ds_read_b128 v[164:167], v5 offset:32
    ds_read_b128 v[168:171], v5 offset:64
    ds_read_b128 v[172:175], v5 offset:96
    ds_read_b128 v[176:179], v5 offset:128
    ds_read_b128 v[180:183], v5 offset:160
    ds_read_b128 v[184:187], v5 offset:192
    ds_read_b128 v[188:191], v5 offset:224
    ds_read_b64 v[14:15], v10
    ds_write_b64 v6, v[18:19] offset:40
    ds_write_b64 v6, v[18:19] offset:3112
    ds_write_b64 v6, v[18:19] offset:6184
    s_waitcnt lgkmcnt(12)
    v_mul_f32 v152, s62, v145
    v_mul_f32 v153, s63, v145
    v_mul_f32 v154, s64, v145
    v_cndmask_b32 v155, v152, v153, vcc
    v_mul_f32 v156, s62, v149
    v_mul_f32 v157, s63, v149
    v_mul_f32 v158, s64, v149
    v_cndmask_b32 v159, v156, v157, vcc
    s_waitcnt lgkmcnt(3)
    v_pk_fma_f32 v[22:23], v[144:145], v[160:161], v[32:33] op_sel_hi:[0,1,1]
    v_pk_fma_f32 v[24:25], v[144:145], v[162:163], v[34:35] op_sel_hi:[0,1,1]
    v_pk_mul_f32 v[22:23], v[22:23], v[152:153] op_sel:[0,0] op_sel_hi:[1,0]
    v_pk_mul_f32 v[24:25], v[24:25], v[152:153] op_sel:[0,0] op_sel_hi:[1,0]
    v_cvt_pk_bf16_f32 v18, v22, v23
    v_cvt_pk_bf16_f32 v19, v24, v25
    ds_write_b64 v30, v[18:19] offset:0
    v_pk_fma_f32 v[26:27], v[144:145], v[164:165], v[36:37] op_sel_hi:[0,1,1]
    v_pk_fma_f32 v[28:29], v[144:145], v[166:167], v[38:39] op_sel_hi:[0,1,1]
    v_pk_mul_f32 v[26:27], v[26:27], v[152:153] op_sel:[0,0] op_sel_hi:[1,0]
    v_pk_mul_f32 v[28:29], v[28:29], v[152:153] op_sel:[0,0] op_sel_hi:[1,0]
    v_cvt_pk_bf16_f32 v20, v26, v27
    v_cvt_pk_bf16_f32 v21, v28, v29
    ds_write_b64 v30, v[20:21] offset:16
    v_pk_fma_f32 v[22:23], v[144:145], v[168:169], v[40:41] op_sel_hi:[0,1,1]
    v_pk_fma_f32 v[24:25], v[144:145], v[170:171], v[42:43] op_sel_hi:[0,1,1]
    v_pk_mul_f32 v[22:23], v[22:23], v[154:155] op_sel:[0,1] op_sel_hi:[1,1]
    v_pk_mul_f32 v[24:25], v[24:25], v[154:155] op_sel:[0,1] op_sel_hi:[1,1]
    v_cvt_pk_bf16_f32 v18, v22, v23
    v_cvt_pk_bf16_f32 v19, v24, v25
    ds_write_b64 v31, v[18:19] offset:32
    v_pk_fma_f32 v[26:27], v[144:145], v[172:173], v[44:45] op_sel_hi:[0,1,1]
    v_pk_fma_f32 v[28:29], v[144:145], v[174:175], v[46:47] op_sel_hi:[0,1,1]
    v_pk_mul_f32 v[26:27], v[26:27], v[152:153] op_sel:[0,1] op_sel_hi:[1,1]
    v_pk_mul_f32 v[28:29], v[28:29], v[152:153] op_sel:[0,1] op_sel_hi:[1,1]
    v_cvt_pk_bf16_f32 v20, v26, v27
    v_cvt_pk_bf16_f32 v21, v28, v29
    ds_write_b64 v30, v[20:21] offset:3080
    v_pk_fma_f32 v[22:23], v[148:149], v[160:161], v[48:49] op_sel_hi:[0,1,1]
    v_pk_fma_f32 v[24:25], v[148:149], v[162:163], v[50:51] op_sel_hi:[0,1,1]
    v_pk_mul_f32 v[22:23], v[22:23], v[156:157] op_sel:[0,0] op_sel_hi:[1,0]
    v_pk_mul_f32 v[24:25], v[24:25], v[156:157] op_sel:[0,0] op_sel_hi:[1,0]
    v_cvt_pk_bf16_f32 v18, v22, v23
    v_cvt_pk_bf16_f32 v19, v24, v25
    ds_write_b64 v11, v[18:19] offset:0
    v_pk_fma_f32 v[26:27], v[148:149], v[164:165], v[52:53] op_sel_hi:[0,1,1]
    v_pk_fma_f32 v[28:29], v[148:149], v[166:167], v[54:55] op_sel_hi:[0,1,1]
    v_pk_mul_f32 v[26:27], v[26:27], v[156:157] op_sel:[0,0] op_sel_hi:[1,0]
    v_pk_mul_f32 v[28:29], v[28:29], v[156:157] op_sel:[0,0] op_sel_hi:[1,0]
    v_cvt_pk_bf16_f32 v20, v26, v27
    v_cvt_pk_bf16_f32 v21, v28, v29
    ds_write_b64 v11, v[20:21] offset:16
    v_pk_fma_f32 v[22:23], v[148:149], v[168:169], v[56:57] op_sel_hi:[0,1,1]
    v_pk_fma_f32 v[24:25], v[148:149], v[170:171], v[58:59] op_sel_hi:[0,1,1]
    v_pk_mul_f32 v[22:23], v[22:23], v[158:159] op_sel:[0,1] op_sel_hi:[1,1]
    v_pk_mul_f32 v[24:25], v[24:25], v[158:159] op_sel:[0,1] op_sel_hi:[1,1]
    v_cvt_pk_bf16_f32 v18, v22, v23
    v_cvt_pk_bf16_f32 v19, v24, v25
    ds_write_b64 v12, v[18:19] offset:32
    v_pk_fma_f32 v[26:27], v[148:149], v[172:173], v[60:61] op_sel_hi:[0,1,1]
    v_pk_fma_f32 v[28:29], v[148:149], v[174:175], v[62:63] op_sel_hi:[0,1,1]
    v_pk_mul_f32 v[26:27], v[26:27], v[156:157] op_sel:[0,1] op_sel_hi:[1,1]
    v_pk_mul_f32 v[28:29], v[28:29], v[156:157] op_sel:[0,1] op_sel_hi:[1,1]
    v_cvt_pk_bf16_f32 v20, v26, v27
    v_cvt_pk_bf16_f32 v21, v28, v29
    ds_write_b64 v11, v[20:21] offset:3080
    s_waitcnt lgkmcnt(0)
    s_add_u32 s61, s54, 0
    s_cmp_ge_u32 s61, 64
    s_cbranch_scc1 parallel_sum__softmax_full_mha__mixer_channel_mlp__prompt_kernel_v0
    ds_read_b128 v[32:35], v7 offset:0
    ds_read_b128 v[36:39], v7 offset:1024
    ds_read_b128 v[40:43], v7 offset:2048
    s_mul_i32 s60, s61, 98304
    s_mul_i32 s61, s55, 3072
    s_add_u32 s60, s60, s61
    s_waitcnt lgkmcnt(2)
    buffer_store_dwordx4 v[32:35], v17, s[4:7], s60 offen offset:0 sc1
    s_waitcnt lgkmcnt(1)
    buffer_store_dwordx4 v[36:39], v17, s[4:7], s60 offen offset:1024 sc1
    s_waitcnt lgkmcnt(0)
    buffer_store_dwordx4 v[40:43], v17, s[4:7], s60 offen offset:2048 sc1
    s_branch parallel_sum__softmax_full_mha__mixer_channel_mlp__prompt_kernel_ve0
parallel_sum__softmax_full_mha__mixer_channel_mlp__prompt_kernel_v0:
    ds_read_b64_tr_b16 v[32:33], v9 offset:0
    ds_read_b64_tr_b16 v[34:35], v9 offset:192
    ds_read_b64_tr_b16 v[36:37], v9 offset:768
    ds_read_b64_tr_b16 v[38:39], v9 offset:960
    ds_read_b64_tr_b16 v[40:41], v9 offset:1536
    ds_read_b64_tr_b16 v[42:43], v9 offset:1728
    ds_read_b64_tr_b16 v[44:45], v9 offset:2304
    ds_read_b64_tr_b16 v[46:47], v9 offset:2496
    s_sub_u32 s60, s61, 64
    s_lshl_b32 s60, s60, 17
    s_lshl_b32 s61, s55, 12
    s_add_u32 s60, s60, s61
    s_add_u32 s60, s60, 6291456
    s_mov_b64 exec, s[66:67]
    s_waitcnt lgkmcnt(6)
    buffer_store_dwordx4 v[32:35], v17, s[4:7], s60 offen offset:0 sc1
    s_waitcnt lgkmcnt(4)
    buffer_store_dwordx4 v[36:39], v17, s[4:7], s60 offen offset:1024 sc1
    s_waitcnt lgkmcnt(2)
    buffer_store_dwordx4 v[40:43], v17, s[4:7], s60 offen offset:2048 sc1
    s_waitcnt lgkmcnt(0)
    buffer_store_dwordx4 v[44:47], v17, s[4:7], s60 offen offset:3072 sc1
    s_mov_b64 exec, -1
parallel_sum__softmax_full_mha__mixer_channel_mlp__prompt_kernel_ve0:
    v_pk_fma_f32 v[22:23], v[144:145], v[176:177], v[64:65] op_sel_hi:[0,1,1]
    v_pk_fma_f32 v[24:25], v[144:145], v[178:179], v[66:67] op_sel_hi:[0,1,1]
    v_pk_mul_f32 v[22:23], v[22:23], v[152:153] op_sel:[0,1] op_sel_hi:[1,1]
    v_pk_mul_f32 v[24:25], v[24:25], v[152:153] op_sel:[0,1] op_sel_hi:[1,1]
    v_cvt_pk_bf16_f32 v18, v22, v23
    v_cvt_pk_bf16_f32 v19, v24, v25
    ds_write_b64 v30, v[18:19] offset:3096
    v_pk_fma_f32 v[26:27], v[144:145], v[180:181], v[68:69] op_sel_hi:[0,1,1]
    v_pk_fma_f32 v[28:29], v[144:145], v[182:183], v[70:71] op_sel_hi:[0,1,1]
    v_pk_mul_f32 v[26:27], v[26:27], v[154:155] op_sel:[0,0] op_sel_hi:[1,0]
    v_pk_mul_f32 v[28:29], v[28:29], v[154:155] op_sel:[0,0] op_sel_hi:[1,0]
    v_cvt_pk_bf16_f32 v20, v26, v27
    v_cvt_pk_bf16_f32 v21, v28, v29
    ds_write_b64 v30, v[20:21] offset:6144
    v_pk_fma_f32 v[22:23], v[144:145], v[184:185], v[72:73] op_sel_hi:[0,1,1]
    v_pk_fma_f32 v[24:25], v[144:145], v[186:187], v[74:75] op_sel_hi:[0,1,1]
    v_pk_mul_f32 v[22:23], v[22:23], v[154:155] op_sel:[0,0] op_sel_hi:[1,0]
    v_pk_mul_f32 v[24:25], v[24:25], v[154:155] op_sel:[0,0] op_sel_hi:[1,0]
    v_cvt_pk_bf16_f32 v18, v22, v23
    v_cvt_pk_bf16_f32 v19, v24, v25
    ds_write_b64 v30, v[18:19] offset:6160
    v_pk_fma_f32 v[26:27], v[144:145], v[188:189], v[76:77] op_sel_hi:[0,1,1]
    v_pk_fma_f32 v[28:29], v[144:145], v[190:191], v[78:79] op_sel_hi:[0,1,1]
    v_pk_mul_f32 v[26:27], v[26:27], v[154:155] op_sel:[0,0] op_sel_hi:[1,0]
    v_pk_mul_f32 v[28:29], v[28:29], v[154:155] op_sel:[0,0] op_sel_hi:[1,0]
    v_cvt_pk_bf16_f32 v20, v26, v27
    v_cvt_pk_bf16_f32 v21, v28, v29
    ds_write_b64 v31, v[20:21] offset:6176
    v_pk_fma_f32 v[22:23], v[148:149], v[176:177], v[80:81] op_sel_hi:[0,1,1]
    v_pk_fma_f32 v[24:25], v[148:149], v[178:179], v[82:83] op_sel_hi:[0,1,1]
    v_pk_mul_f32 v[22:23], v[22:23], v[156:157] op_sel:[0,1] op_sel_hi:[1,1]
    v_pk_mul_f32 v[24:25], v[24:25], v[156:157] op_sel:[0,1] op_sel_hi:[1,1]
    v_cvt_pk_bf16_f32 v18, v22, v23
    v_cvt_pk_bf16_f32 v19, v24, v25
    ds_write_b64 v11, v[18:19] offset:3096
    v_pk_fma_f32 v[26:27], v[148:149], v[180:181], v[84:85] op_sel_hi:[0,1,1]
    v_pk_fma_f32 v[28:29], v[148:149], v[182:183], v[86:87] op_sel_hi:[0,1,1]
    v_pk_mul_f32 v[26:27], v[26:27], v[158:159] op_sel:[0,0] op_sel_hi:[1,0]
    v_pk_mul_f32 v[28:29], v[28:29], v[158:159] op_sel:[0,0] op_sel_hi:[1,0]
    v_cvt_pk_bf16_f32 v20, v26, v27
    v_cvt_pk_bf16_f32 v21, v28, v29
    ds_write_b64 v11, v[20:21] offset:6144
    v_pk_fma_f32 v[22:23], v[148:149], v[184:185], v[88:89] op_sel_hi:[0,1,1]
    v_pk_fma_f32 v[24:25], v[148:149], v[186:187], v[90:91] op_sel_hi:[0,1,1]
    v_pk_mul_f32 v[22:23], v[22:23], v[158:159] op_sel:[0,0] op_sel_hi:[1,0]
    v_pk_mul_f32 v[24:25], v[24:25], v[158:159] op_sel:[0,0] op_sel_hi:[1,0]
    v_cvt_pk_bf16_f32 v18, v22, v23
    v_cvt_pk_bf16_f32 v19, v24, v25
    ds_write_b64 v11, v[18:19] offset:6160
    v_pk_fma_f32 v[26:27], v[148:149], v[188:189], v[92:93] op_sel_hi:[0,1,1]
    v_pk_fma_f32 v[28:29], v[148:149], v[190:191], v[94:95] op_sel_hi:[0,1,1]
    v_pk_mul_f32 v[26:27], v[26:27], v[158:159] op_sel:[0,0] op_sel_hi:[1,0]
    v_pk_mul_f32 v[28:29], v[28:29], v[158:159] op_sel:[0,0] op_sel_hi:[1,0]
    v_cvt_pk_bf16_f32 v20, v26, v27
    v_cvt_pk_bf16_f32 v21, v28, v29
    ds_write_b64 v12, v[20:21] offset:6176
    s_waitcnt lgkmcnt(0)
    s_add_u32 s61, s54, 1
    s_cmp_ge_u32 s61, 64
    s_cbranch_scc1 parallel_sum__softmax_full_mha__mixer_channel_mlp__prompt_kernel_v1
    ds_read_b128 v[48:51], v7 offset:3072
    ds_read_b128 v[52:55], v7 offset:4096
    ds_read_b128 v[56:59], v7 offset:5120
    s_mul_i32 s60, s61, 98304
    s_mul_i32 s61, s55, 3072
    s_add_u32 s60, s60, s61
    s_waitcnt lgkmcnt(2)
    buffer_store_dwordx4 v[48:51], v17, s[4:7], s60 offen offset:0 sc1
    s_waitcnt lgkmcnt(1)
    buffer_store_dwordx4 v[52:55], v17, s[4:7], s60 offen offset:1024 sc1
    s_waitcnt lgkmcnt(0)
    buffer_store_dwordx4 v[56:59], v17, s[4:7], s60 offen offset:2048 sc1
    s_branch parallel_sum__softmax_full_mha__mixer_channel_mlp__prompt_kernel_ve1
parallel_sum__softmax_full_mha__mixer_channel_mlp__prompt_kernel_v1:
    ds_read_b64_tr_b16 v[48:49], v9 offset:3072
    ds_read_b64_tr_b16 v[50:51], v9 offset:3264
    ds_read_b64_tr_b16 v[52:53], v9 offset:3840
    ds_read_b64_tr_b16 v[54:55], v9 offset:4032
    ds_read_b64_tr_b16 v[56:57], v9 offset:4608
    ds_read_b64_tr_b16 v[58:59], v9 offset:4800
    ds_read_b64_tr_b16 v[60:61], v9 offset:5376
    ds_read_b64_tr_b16 v[62:63], v9 offset:5568
    s_sub_u32 s60, s61, 64
    s_lshl_b32 s60, s60, 17
    s_lshl_b32 s61, s55, 12
    s_add_u32 s60, s60, s61
    s_add_u32 s60, s60, 6291456
    s_mov_b64 exec, s[66:67]
    s_waitcnt lgkmcnt(6)
    buffer_store_dwordx4 v[48:51], v17, s[4:7], s60 offen offset:0 sc1
    s_waitcnt lgkmcnt(4)
    buffer_store_dwordx4 v[52:55], v17, s[4:7], s60 offen offset:1024 sc1
    s_waitcnt lgkmcnt(2)
    buffer_store_dwordx4 v[56:59], v17, s[4:7], s60 offen offset:2048 sc1
    s_waitcnt lgkmcnt(0)
    buffer_store_dwordx4 v[60:63], v17, s[4:7], s60 offen offset:3072 sc1
    s_mov_b64 exec, -1
parallel_sum__softmax_full_mha__mixer_channel_mlp__prompt_kernel_ve1:
    s_add_u32 s61, s54, 2
    s_cmp_ge_u32 s61, 64
    s_cbranch_scc1 parallel_sum__softmax_full_mha__mixer_channel_mlp__prompt_kernel_v2
    ds_read_b128 v[64:67], v7 offset:6144
    ds_read_b128 v[68:71], v7 offset:7168
    ds_read_b128 v[72:75], v7 offset:8192
    s_mul_i32 s60, s61, 98304
    s_mul_i32 s61, s55, 3072
    s_add_u32 s60, s60, s61
    s_waitcnt lgkmcnt(2)
    buffer_store_dwordx4 v[64:67], v17, s[4:7], s60 offen offset:0 sc1
    s_waitcnt lgkmcnt(1)
    buffer_store_dwordx4 v[68:71], v17, s[4:7], s60 offen offset:1024 sc1
    s_waitcnt lgkmcnt(0)
    buffer_store_dwordx4 v[72:75], v17, s[4:7], s60 offen offset:2048 sc1
    s_branch parallel_sum__softmax_full_mha__mixer_channel_mlp__prompt_kernel_ve2
parallel_sum__softmax_full_mha__mixer_channel_mlp__prompt_kernel_v2:
    ds_read_b64_tr_b16 v[64:65], v9 offset:6144
    ds_read_b64_tr_b16 v[66:67], v9 offset:6336
    ds_read_b64_tr_b16 v[68:69], v9 offset:6912
    ds_read_b64_tr_b16 v[70:71], v9 offset:7104
    ds_read_b64_tr_b16 v[72:73], v9 offset:7680
    ds_read_b64_tr_b16 v[74:75], v9 offset:7872
    ds_read_b64_tr_b16 v[76:77], v9 offset:8448
    ds_read_b64_tr_b16 v[78:79], v9 offset:8640
    s_sub_u32 s60, s61, 64
    s_lshl_b32 s60, s60, 17
    s_lshl_b32 s61, s55, 12
    s_add_u32 s60, s60, s61
    s_add_u32 s60, s60, 6291456
    s_mov_b64 exec, s[66:67]
    s_waitcnt lgkmcnt(6)
    buffer_store_dwordx4 v[64:67], v17, s[4:7], s60 offen offset:0 sc1
    s_waitcnt lgkmcnt(4)
    buffer_store_dwordx4 v[68:71], v17, s[4:7], s60 offen offset:1024 sc1
    s_waitcnt lgkmcnt(2)
    buffer_store_dwordx4 v[72:75], v17, s[4:7], s60 offen offset:2048 sc1
    s_waitcnt lgkmcnt(0)
    buffer_store_dwordx4 v[76:79], v17, s[4:7], s60 offen offset:3072 sc1
    s_mov_b64 exec, -1
parallel_sum__softmax_full_mha__mixer_channel_mlp__prompt_kernel_ve2:
    s_lshl_b32 s61, s53, 8
    v_lshl_add_u32 v12, v3, 4, s61
    v_add_u32 v13, 137728, v12
    v_add_u32 v12, 138240, v12
    ds_read_b128 v[160:163], v13 offset:0
    ds_read_b128 v[176:179], v12 offset:0
    ds_read_b128 v[164:167], v13 offset:32
    ds_read_b128 v[180:183], v12 offset:32
    ds_read_b128 v[168:171], v13 offset:64
    ds_read_b128 v[184:187], v12 offset:64
    ds_read_b128 v[172:175], v13 offset:96
    ds_read_b128 v[188:191], v12 offset:96
    v_mov_b32 v4, 0xbdd2d3e8
    v_mov_b32 v5, 0xc0135761
    s_mul_i32 s60, s3, 10240
    s_add_u32 s60, s60, 49152
    v_add_u32 v6, s60, v17
    s_lshl_b32 s60, s47, 4
    s_add_u32 s60, s60, s46
    s_lshl_b32 s60, s60, 2
    s_add_u32 s60, s60, s3
    s_lshl_b32 s60, s60, 3
    s_add_u32 s58, s60, 24117248
    s_waitcnt lgkmcnt(0)
    v_pk_fma_f32 v[80:81], v[146:147], v[160:161], v[176:177] op_sel:[1,0,0] op_sel_hi:[1,1,1]
    v_pk_fma_f32 v[82:83], v[146:147], v[162:163], v[178:179] op_sel:[1,0,0] op_sel_hi:[1,1,1]
    v_pk_fma_f32 v[84:85], v[146:147], v[164:165], v[180:181] op_sel:[1,0,0] op_sel_hi:[1,1,1]
    v_pk_fma_f32 v[86:87], v[146:147], v[166:167], v[182:183] op_sel:[1,0,0] op_sel_hi:[1,1,1]
    v_pk_fma_f32 v[88:89], v[146:147], v[168:169], v[184:185] op_sel:[1,0,0] op_sel_hi:[1,1,1]
    v_pk_fma_f32 v[90:91], v[146:147], v[170:171], v[186:187] op_sel:[1,0,0] op_sel_hi:[1,1,1]
    v_pk_fma_f32 v[92:93], v[146:147], v[172:173], v[188:189] op_sel:[1,0,0] op_sel_hi:[1,1,1]
    v_pk_fma_f32 v[94:95], v[146:147], v[174:175], v[190:191] op_sel:[1,0,0] op_sel_hi:[1,1,1]
    v_pk_fma_f32 v[80:81], v[96:97], v[146:147], v[80:81] op_sel_hi:[1,0,1]
    v_pk_fma_f32 v[82:83], v[98:99], v[146:147], v[82:83] op_sel_hi:[1,0,1]
    v_pk_fma_f32 v[84:85], v[100:101], v[146:147], v[84:85] op_sel_hi:[1,0,1]
    v_pk_fma_f32 v[86:87], v[102:103], v[146:147], v[86:87] op_sel_hi:[1,0,1]
    v_pk_fma_f32 v[88:89], v[104:105], v[146:147], v[88:89] op_sel_hi:[1,0,1]
    v_pk_fma_f32 v[90:91], v[106:107], v[146:147], v[90:91] op_sel_hi:[1,0,1]
    v_pk_fma_f32 v[92:93], v[108:109], v[146:147], v[92:93] op_sel_hi:[1,0,1]
    v_pk_fma_f32 v[94:95], v[110:111], v[146:147], v[94:95] op_sel_hi:[1,0,1]
    v_pk_mul_f32 v[96:97], v[80:81], v[80:81]
    v_pk_mul_f32 v[98:99], v[82:83], v[82:83]
    v_pk_mul_f32 v[100:101], v[84:85], v[84:85]
    v_pk_mul_f32 v[102:103], v[86:87], v[86:87]
    v_pk_mul_f32 v[104:105], v[88:89], v[88:89]
    v_pk_mul_f32 v[106:107], v[90:91], v[90:91]
    v_pk_mul_f32 v[108:109], v[92:93], v[92:93]
    v_pk_mul_f32 v[110:111], v[94:95], v[94:95]
    v_pk_fma_f32 v[96:97], v[96:97], v[4:5], v[4:5] op_sel:[0,0,1] op_sel_hi:[1,0,1]
    v_pk_fma_f32 v[98:99], v[98:99], v[4:5], v[4:5] op_sel:[0,0,1] op_sel_hi:[1,0,1]
    v_pk_fma_f32 v[100:101], v[100:101], v[4:5], v[4:5] op_sel:[0,0,1] op_sel_hi:[1,0,1]
    v_pk_fma_f32 v[102:103], v[102:103], v[4:5], v[4:5] op_sel:[0,0,1] op_sel_hi:[1,0,1]
    v_pk_fma_f32 v[104:105], v[104:105], v[4:5], v[4:5] op_sel:[0,0,1] op_sel_hi:[1,0,1]
    v_pk_fma_f32 v[106:107], v[106:107], v[4:5], v[4:5] op_sel:[0,0,1] op_sel_hi:[1,0,1]
    v_pk_fma_f32 v[108:109], v[108:109], v[4:5], v[4:5] op_sel:[0,0,1] op_sel_hi:[1,0,1]
    v_pk_fma_f32 v[110:111], v[110:111], v[4:5], v[4:5] op_sel:[0,0,1] op_sel_hi:[1,0,1]
    v_pk_mul_f32 v[96:97], v[96:97], v[80:81]
    v_pk_mul_f32 v[98:99], v[98:99], v[82:83]
    v_pk_mul_f32 v[100:101], v[100:101], v[84:85]
    v_pk_mul_f32 v[102:103], v[102:103], v[86:87]
    v_pk_mul_f32 v[104:105], v[104:105], v[88:89]
    v_pk_mul_f32 v[106:107], v[106:107], v[90:91]
    v_pk_mul_f32 v[108:109], v[108:109], v[92:93]
    v_pk_mul_f32 v[110:111], v[110:111], v[94:95]
    v_exp_f32 v96, v96
    v_exp_f32 v97, v97
    v_exp_f32 v98, v98
    v_exp_f32 v99, v99
    v_exp_f32 v100, v100
    v_exp_f32 v101, v101
    v_exp_f32 v102, v102
    v_exp_f32 v103, v103
    v_exp_f32 v104, v104
    v_exp_f32 v105, v105
    v_exp_f32 v106, v106
    v_exp_f32 v107, v107
    v_exp_f32 v108, v108
    v_exp_f32 v109, v109
    v_exp_f32 v110, v110
    v_exp_f32 v111, v111
    v_pk_add_f32 v[96:97], v[96:97], 1.0 op_sel_hi:[1,0]
    v_pk_add_f32 v[98:99], v[98:99], 1.0 op_sel_hi:[1,0]
    v_pk_add_f32 v[100:101], v[100:101], 1.0 op_sel_hi:[1,0]
    v_pk_add_f32 v[102:103], v[102:103], 1.0 op_sel_hi:[1,0]
    v_pk_add_f32 v[104:105], v[104:105], 1.0 op_sel_hi:[1,0]
    v_pk_add_f32 v[106:107], v[106:107], 1.0 op_sel_hi:[1,0]
    v_pk_add_f32 v[108:109], v[108:109], 1.0 op_sel_hi:[1,0]
    v_pk_add_f32 v[110:111], v[110:111], 1.0 op_sel_hi:[1,0]
    v_rcp_f32 v96, v96
    v_rcp_f32 v97, v97
    v_rcp_f32 v98, v98
    v_rcp_f32 v99, v99
    v_rcp_f32 v100, v100
    v_rcp_f32 v101, v101
    v_rcp_f32 v102, v102
    v_rcp_f32 v103, v103
    v_rcp_f32 v104, v104
    v_rcp_f32 v105, v105
    v_rcp_f32 v106, v106
    v_rcp_f32 v107, v107
    v_rcp_f32 v108, v108
    v_rcp_f32 v109, v109
    v_rcp_f32 v110, v110
    v_rcp_f32 v111, v111
    v_pk_mul_f32 v[80:81], v[80:81], v[96:97]
    v_pk_mul_f32 v[82:83], v[82:83], v[98:99]
    v_pk_mul_f32 v[84:85], v[84:85], v[100:101]
    v_pk_mul_f32 v[86:87], v[86:87], v[102:103]
    v_pk_mul_f32 v[88:89], v[88:89], v[104:105]
    v_pk_mul_f32 v[90:91], v[90:91], v[106:107]
    v_pk_mul_f32 v[92:93], v[92:93], v[108:109]
    v_pk_mul_f32 v[94:95], v[94:95], v[110:111]
    v_cvt_pk_bf16_f32 v96, v80, v81
    v_cvt_pk_bf16_f32 v97, v82, v83
    v_cvt_pk_bf16_f32 v98, v84, v85
    v_cvt_pk_bf16_f32 v99, v86, v87
    v_cvt_pk_bf16_f32 v100, v88, v89
    v_cvt_pk_bf16_f32 v101, v90, v91
    v_cvt_pk_bf16_f32 v102, v92, v93
    v_cvt_pk_bf16_f32 v103, v94, v95
    ds_write_b128 v6, v[96:99] offset:0
    ds_write_b128 v6, v[100:103] offset:1024
    v_pk_fma_f32 v[80:81], v[150:151], v[160:161], v[176:177] op_sel:[1,0,0] op_sel_hi:[1,1,1]
    v_pk_fma_f32 v[82:83], v[150:151], v[162:163], v[178:179] op_sel:[1,0,0] op_sel_hi:[1,1,1]
    v_pk_fma_f32 v[84:85], v[150:151], v[164:165], v[180:181] op_sel:[1,0,0] op_sel_hi:[1,1,1]
    v_pk_fma_f32 v[86:87], v[150:151], v[166:167], v[182:183] op_sel:[1,0,0] op_sel_hi:[1,1,1]
    v_pk_fma_f32 v[88:89], v[150:151], v[168:169], v[184:185] op_sel:[1,0,0] op_sel_hi:[1,1,1]
    v_pk_fma_f32 v[90:91], v[150:151], v[170:171], v[186:187] op_sel:[1,0,0] op_sel_hi:[1,1,1]
    v_pk_fma_f32 v[92:93], v[150:151], v[172:173], v[188:189] op_sel:[1,0,0] op_sel_hi:[1,1,1]
    v_pk_fma_f32 v[94:95], v[150:151], v[174:175], v[190:191] op_sel:[1,0,0] op_sel_hi:[1,1,1]
    s_movk_i32 s61, 128
    v_lshl_add_u32 v12, v3, 4, s61
    v_add_u32 v13, 137728, v12
    v_add_u32 v12, 138240, v12
    ds_read_b128 v[160:163], v13 offset:0
    ds_read_b128 v[176:179], v12 offset:0
    ds_read_b128 v[164:167], v13 offset:32
    ds_read_b128 v[180:183], v12 offset:32
    ds_read_b128 v[168:171], v13 offset:64
    ds_read_b128 v[184:187], v12 offset:64
    ds_read_b128 v[172:175], v13 offset:96
    ds_read_b128 v[188:191], v12 offset:96
    v_pk_fma_f32 v[80:81], v[112:113], v[150:151], v[80:81] op_sel_hi:[1,0,1]
    v_pk_fma_f32 v[82:83], v[114:115], v[150:151], v[82:83] op_sel_hi:[1,0,1]
    v_pk_fma_f32 v[84:85], v[116:117], v[150:151], v[84:85] op_sel_hi:[1,0,1]
    v_pk_fma_f32 v[86:87], v[118:119], v[150:151], v[86:87] op_sel_hi:[1,0,1]
    v_pk_fma_f32 v[88:89], v[120:121], v[150:151], v[88:89] op_sel_hi:[1,0,1]
    v_pk_fma_f32 v[90:91], v[122:123], v[150:151], v[90:91] op_sel_hi:[1,0,1]
    v_pk_fma_f32 v[92:93], v[124:125], v[150:151], v[92:93] op_sel_hi:[1,0,1]
    v_pk_fma_f32 v[94:95], v[126:127], v[150:151], v[94:95] op_sel_hi:[1,0,1]
    v_pk_mul_f32 v[112:113], v[80:81], v[80:81]
    v_pk_mul_f32 v[114:115], v[82:83], v[82:83]
    v_pk_mul_f32 v[116:117], v[84:85], v[84:85]
    v_pk_mul_f32 v[118:119], v[86:87], v[86:87]
    v_pk_mul_f32 v[120:121], v[88:89], v[88:89]
    v_pk_mul_f32 v[122:123], v[90:91], v[90:91]
    v_pk_mul_f32 v[124:125], v[92:93], v[92:93]
    v_pk_mul_f32 v[126:127], v[94:95], v[94:95]
    v_pk_fma_f32 v[112:113], v[112:113], v[4:5], v[4:5] op_sel:[0,0,1] op_sel_hi:[1,0,1]
    v_pk_fma_f32 v[114:115], v[114:115], v[4:5], v[4:5] op_sel:[0,0,1] op_sel_hi:[1,0,1]
    v_pk_fma_f32 v[116:117], v[116:117], v[4:5], v[4:5] op_sel:[0,0,1] op_sel_hi:[1,0,1]
    v_pk_fma_f32 v[118:119], v[118:119], v[4:5], v[4:5] op_sel:[0,0,1] op_sel_hi:[1,0,1]
    v_pk_fma_f32 v[120:121], v[120:121], v[4:5], v[4:5] op_sel:[0,0,1] op_sel_hi:[1,0,1]
    v_pk_fma_f32 v[122:123], v[122:123], v[4:5], v[4:5] op_sel:[0,0,1] op_sel_hi:[1,0,1]
    v_pk_fma_f32 v[124:125], v[124:125], v[4:5], v[4:5] op_sel:[0,0,1] op_sel_hi:[1,0,1]
    v_pk_fma_f32 v[126:127], v[126:127], v[4:5], v[4:5] op_sel:[0,0,1] op_sel_hi:[1,0,1]
    v_pk_mul_f32 v[112:113], v[112:113], v[80:81]
    v_pk_mul_f32 v[114:115], v[114:115], v[82:83]
    v_pk_mul_f32 v[116:117], v[116:117], v[84:85]
    v_pk_mul_f32 v[118:119], v[118:119], v[86:87]
    v_pk_mul_f32 v[120:121], v[120:121], v[88:89]
    v_pk_mul_f32 v[122:123], v[122:123], v[90:91]
    v_pk_mul_f32 v[124:125], v[124:125], v[92:93]
    v_pk_mul_f32 v[126:127], v[126:127], v[94:95]
    v_exp_f32 v112, v112
    v_exp_f32 v113, v113
    v_exp_f32 v114, v114
    v_exp_f32 v115, v115
    v_exp_f32 v116, v116
    v_exp_f32 v117, v117
    v_exp_f32 v118, v118
    v_exp_f32 v119, v119
    v_exp_f32 v120, v120
    v_exp_f32 v121, v121
    v_exp_f32 v122, v122
    v_exp_f32 v123, v123
    v_exp_f32 v124, v124
    v_exp_f32 v125, v125
    v_exp_f32 v126, v126
    v_exp_f32 v127, v127
    s_waitcnt vmcnt(0)
    s_mov_b64 exec, 1
    buffer_store_dwordx2 v[14:15], v16, s[4:7], s58 offen sc1
    s_mov_b64 exec, -1
    v_pk_add_f32 v[112:113], v[112:113], 1.0 op_sel_hi:[1,0]
    v_pk_add_f32 v[114:115], v[114:115], 1.0 op_sel_hi:[1,0]
    v_pk_add_f32 v[116:117], v[116:117], 1.0 op_sel_hi:[1,0]
    v_pk_add_f32 v[118:119], v[118:119], 1.0 op_sel_hi:[1,0]
    v_pk_add_f32 v[120:121], v[120:121], 1.0 op_sel_hi:[1,0]
    v_pk_add_f32 v[122:123], v[122:123], 1.0 op_sel_hi:[1,0]
    v_pk_add_f32 v[124:125], v[124:125], 1.0 op_sel_hi:[1,0]
    v_pk_add_f32 v[126:127], v[126:127], 1.0 op_sel_hi:[1,0]
    v_rcp_f32 v112, v112
    v_rcp_f32 v113, v113
    v_rcp_f32 v114, v114
    v_rcp_f32 v115, v115
    v_rcp_f32 v116, v116
    v_rcp_f32 v117, v117
    v_rcp_f32 v118, v118
    v_rcp_f32 v119, v119
    v_rcp_f32 v120, v120
    v_rcp_f32 v121, v121
    v_rcp_f32 v122, v122
    v_rcp_f32 v123, v123
    v_rcp_f32 v124, v124
    v_rcp_f32 v125, v125
    v_rcp_f32 v126, v126
    v_rcp_f32 v127, v127
    v_pk_mul_f32 v[80:81], v[80:81], v[112:113]
    v_pk_mul_f32 v[82:83], v[82:83], v[114:115]
    v_pk_mul_f32 v[84:85], v[84:85], v[116:117]
    v_pk_mul_f32 v[86:87], v[86:87], v[118:119]
    v_pk_mul_f32 v[88:89], v[88:89], v[120:121]
    v_pk_mul_f32 v[90:91], v[90:91], v[122:123]
    v_pk_mul_f32 v[92:93], v[92:93], v[124:125]
    v_pk_mul_f32 v[94:95], v[94:95], v[126:127]
    v_cvt_pk_bf16_f32 v112, v80, v81
    v_cvt_pk_bf16_f32 v113, v82, v83
    v_cvt_pk_bf16_f32 v114, v84, v85
    v_cvt_pk_bf16_f32 v115, v86, v87
    v_cvt_pk_bf16_f32 v116, v88, v89
    v_cvt_pk_bf16_f32 v117, v90, v91
    v_cvt_pk_bf16_f32 v118, v92, v93
    v_cvt_pk_bf16_f32 v119, v94, v95
    ds_write_b128 v6, v[112:115] offset:2048
    ds_write_b128 v6, v[116:119] offset:3072
    s_waitcnt lgkmcnt(0)
    v_pk_fma_f32 v[80:81], v[146:147], v[160:161], v[176:177] op_sel:[1,0,0] op_sel_hi:[1,1,1]
    v_pk_fma_f32 v[82:83], v[146:147], v[162:163], v[178:179] op_sel:[1,0,0] op_sel_hi:[1,1,1]
    v_pk_fma_f32 v[84:85], v[146:147], v[164:165], v[180:181] op_sel:[1,0,0] op_sel_hi:[1,1,1]
    v_pk_fma_f32 v[86:87], v[146:147], v[166:167], v[182:183] op_sel:[1,0,0] op_sel_hi:[1,1,1]
    v_pk_fma_f32 v[88:89], v[146:147], v[168:169], v[184:185] op_sel:[1,0,0] op_sel_hi:[1,1,1]
    v_pk_fma_f32 v[90:91], v[146:147], v[170:171], v[186:187] op_sel:[1,0,0] op_sel_hi:[1,1,1]
    v_pk_fma_f32 v[92:93], v[146:147], v[172:173], v[188:189] op_sel:[1,0,0] op_sel_hi:[1,1,1]
    v_pk_fma_f32 v[94:95], v[146:147], v[174:175], v[190:191] op_sel:[1,0,0] op_sel_hi:[1,1,1]
    v_pk_fma_f32 v[80:81], v[128:129], v[146:147], v[80:81] op_sel_hi:[1,0,1]
    v_pk_fma_f32 v[82:83], v[130:131], v[146:147], v[82:83] op_sel_hi:[1,0,1]
    v_pk_fma_f32 v[84:85], v[132:133], v[146:147], v[84:85] op_sel_hi:[1,0,1]
    v_pk_fma_f32 v[86:87], v[134:135], v[146:147], v[86:87] op_sel_hi:[1,0,1]
    v_pk_fma_f32 v[88:89], v[136:137], v[146:147], v[88:89] op_sel_hi:[1,0,1]
    v_pk_fma_f32 v[90:91], v[138:139], v[146:147], v[90:91] op_sel_hi:[1,0,1]
    v_pk_fma_f32 v[92:93], v[140:141], v[146:147], v[92:93] op_sel_hi:[1,0,1]
    v_pk_fma_f32 v[94:95], v[142:143], v[146:147], v[94:95] op_sel_hi:[1,0,1]
    v_pk_mul_f32 v[128:129], v[80:81], v[80:81]
    v_pk_mul_f32 v[130:131], v[82:83], v[82:83]
    v_pk_mul_f32 v[132:133], v[84:85], v[84:85]
    v_pk_mul_f32 v[134:135], v[86:87], v[86:87]
    v_pk_mul_f32 v[136:137], v[88:89], v[88:89]
    v_pk_mul_f32 v[138:139], v[90:91], v[90:91]
    v_pk_mul_f32 v[140:141], v[92:93], v[92:93]
    v_pk_mul_f32 v[142:143], v[94:95], v[94:95]
    v_pk_fma_f32 v[128:129], v[128:129], v[4:5], v[4:5] op_sel:[0,0,1] op_sel_hi:[1,0,1]
    v_pk_fma_f32 v[130:131], v[130:131], v[4:5], v[4:5] op_sel:[0,0,1] op_sel_hi:[1,0,1]
    v_pk_fma_f32 v[132:133], v[132:133], v[4:5], v[4:5] op_sel:[0,0,1] op_sel_hi:[1,0,1]
    v_pk_fma_f32 v[134:135], v[134:135], v[4:5], v[4:5] op_sel:[0,0,1] op_sel_hi:[1,0,1]
    v_pk_fma_f32 v[136:137], v[136:137], v[4:5], v[4:5] op_sel:[0,0,1] op_sel_hi:[1,0,1]
    v_pk_fma_f32 v[138:139], v[138:139], v[4:5], v[4:5] op_sel:[0,0,1] op_sel_hi:[1,0,1]
    v_pk_fma_f32 v[140:141], v[140:141], v[4:5], v[4:5] op_sel:[0,0,1] op_sel_hi:[1,0,1]
    v_pk_fma_f32 v[142:143], v[142:143], v[4:5], v[4:5] op_sel:[0,0,1] op_sel_hi:[1,0,1]
    v_pk_mul_f32 v[128:129], v[128:129], v[80:81]
    v_pk_mul_f32 v[130:131], v[130:131], v[82:83]
    v_pk_mul_f32 v[132:133], v[132:133], v[84:85]
    v_pk_mul_f32 v[134:135], v[134:135], v[86:87]
    v_pk_mul_f32 v[136:137], v[136:137], v[88:89]
    v_pk_mul_f32 v[138:139], v[138:139], v[90:91]
    v_pk_mul_f32 v[140:141], v[140:141], v[92:93]
    v_pk_mul_f32 v[142:143], v[142:143], v[94:95]
    v_exp_f32 v128, v128
    v_exp_f32 v129, v129
    v_exp_f32 v130, v130
    v_exp_f32 v131, v131
    v_exp_f32 v132, v132
    v_exp_f32 v133, v133
    v_exp_f32 v134, v134
    v_exp_f32 v135, v135
    v_exp_f32 v136, v136
    v_exp_f32 v137, v137
    v_exp_f32 v138, v138
    v_exp_f32 v139, v139
    v_exp_f32 v140, v140
    v_exp_f32 v141, v141
    v_exp_f32 v142, v142
    v_exp_f32 v143, v143
    v_pk_add_f32 v[128:129], v[128:129], 1.0 op_sel_hi:[1,0]
    v_pk_add_f32 v[130:131], v[130:131], 1.0 op_sel_hi:[1,0]
    v_pk_add_f32 v[132:133], v[132:133], 1.0 op_sel_hi:[1,0]
    v_pk_add_f32 v[134:135], v[134:135], 1.0 op_sel_hi:[1,0]
    v_pk_add_f32 v[136:137], v[136:137], 1.0 op_sel_hi:[1,0]
    v_pk_add_f32 v[138:139], v[138:139], 1.0 op_sel_hi:[1,0]
    v_pk_add_f32 v[140:141], v[140:141], 1.0 op_sel_hi:[1,0]
    v_pk_add_f32 v[142:143], v[142:143], 1.0 op_sel_hi:[1,0]
    v_rcp_f32 v128, v128
    v_rcp_f32 v129, v129
    v_rcp_f32 v130, v130
    v_rcp_f32 v131, v131
    v_rcp_f32 v132, v132
    v_rcp_f32 v133, v133
    v_rcp_f32 v134, v134
    v_rcp_f32 v135, v135
    v_rcp_f32 v136, v136
    v_rcp_f32 v137, v137
    v_rcp_f32 v138, v138
    v_rcp_f32 v139, v139
    v_rcp_f32 v140, v140
    v_rcp_f32 v141, v141
    v_rcp_f32 v142, v142
    v_rcp_f32 v143, v143
    v_pk_mul_f32 v[80:81], v[80:81], v[128:129]
    v_pk_mul_f32 v[82:83], v[82:83], v[130:131]
    v_pk_mul_f32 v[84:85], v[84:85], v[132:133]
    v_pk_mul_f32 v[86:87], v[86:87], v[134:135]
    v_pk_mul_f32 v[88:89], v[88:89], v[136:137]
    v_pk_mul_f32 v[90:91], v[90:91], v[138:139]
    v_pk_mul_f32 v[92:93], v[92:93], v[140:141]
    v_pk_mul_f32 v[94:95], v[94:95], v[142:143]
    v_cvt_pk_bf16_f32 v128, v80, v81
    v_cvt_pk_bf16_f32 v129, v82, v83
    v_cvt_pk_bf16_f32 v130, v84, v85
    v_cvt_pk_bf16_f32 v131, v86, v87
    v_cvt_pk_bf16_f32 v132, v88, v89
    v_cvt_pk_bf16_f32 v133, v90, v91
    v_cvt_pk_bf16_f32 v134, v92, v93
    v_cvt_pk_bf16_f32 v135, v94, v95
    ds_write_b128 v6, v[128:131] offset:4096
    ds_write_b128 v6, v[132:135] offset:5120
    v_mul_u32_u24 v4, 48, v2
    v_lshl_add_u32 v21, v3, 4, v4
    v_lshlrev_b32 v5, 30, v3
    v_add3_u32 v22, v4, v5, 32
    v_and_b32 v6, 0x13, v2
    v_bfe_u32 v7, v2, 2, 1
    v_lshl_or_b32 v6, v7, 3, v6
    v_bfe_u32 v7, v2, 3, 1
    v_lshl_or_b32 v6, v7, 2, v6
    v_mul_u32_u24 v6, 48, v6
    v_lshl_add_u32 v18, v3, 4, v6
    v_add3_u32 v19, v6, v5, 32
    v_cmp_lt_u32 vcc, 20, v2
    v_mov_b32 v7, 0x40000000
    v_cmp_eq_u32 s[56:57], 0, v3
    v_cndmask_b32 v7, 0, v7, vcc
    v_add_u32 v20, v7, v17
    s_add_u32 s60, s48, 32
    s_mul_i32 s61, s60, 43
    s_lshr_b32 s61, s61, 8
    s_mul_i32 s62, s61, 6
    s_sub_u32 s62, s60, s62
    s_cmp_ge_u32 s62, 3
    s_cselect_b32 s62, 16, 0
    s_lshl_b32 s61, s61, 9
    s_add_u32 s63, s61, s62
    s_add_u32 s60, s48, 64
    s_mul_i32 s61, s60, 43
    s_lshr_b32 s61, s61, 8
    s_mul_i32 s62, s61, 6
    s_sub_u32 s62, s60, s62
    s_cmp_ge_u32 s62, 3
    s_cselect_b32 s62, 16, 0
    s_lshl_b32 s61, s61, 9
    s_add_u32 s64, s61, s62
    s_add_u32 s60, s48, 0
    s_mul_i32 s61, s60, 43
    s_lshr_b32 s61, s61, 8
    s_mul_i32 s62, s61, 6
    s_sub_u32 s62, s60, s62
    s_cmp_ge_u32 s62, 3
    s_cselect_b32 s62, 16, 0
    s_lshl_b32 s61, s61, 9
    s_add_u32 s65, s61, s62
    v_lshrrev_b32 v8, 1, v2
    v_lshlrev_b32 v8, 5, v8
    v_and_b32 v9, 1, v2
    v_lshl_add_u32 v8, v9, 3, v8
    v_mov_b32 v9, s63
    v_mov_b32 v10, s64
    v_cndmask_b32 v9, v10, v9, s[56:57]
    v_and_b32 v11, 1, v2
    v_lshlrev_b32 v11, 3, v11
    s_lshl_b32 s60, s53, 8
    v_add3_u32 v12, v9, v11, s60
    s_lshl_b32 s60, s49, 1
    s_add_u32 s60, s60, s52
    s_lshl_b32 s60, s60, 5
    s_add_u32 s60, s60, s65
    v_add_u32 v11, s60, v11
    v_add_u32 v9, v9, v8
    s_mul_i32 s60, s48, 98304
    s_add_u32 s54, s60, 3145728
    s_lshl_b32 s61, s49, 1
    s_add_u32 s61, s61, s52
    s_mul_i32 s61, s61, 6144
    s_add_u32 s55, s60, s61
    s_mul_i32 s61, s53, 49152
    s_add_u32 s62, s54, s61
    s_lshl_b32 s60, s48, 17
    s_lshl_b32 s61, s53, 16
    s_add_u32 s63, s60, s61
    s_add_u32 s63, s63, 6291456
    v_accvgpr_write_b32 a0, 0
    v_accvgpr_write_b32 a1, 0
    v_accvgpr_write_b32 a2, 0
    v_accvgpr_write_b32 a3, 0
    v_accvgpr_write_b32 a4, 0
    v_accvgpr_write_b32 a5, 0
    v_accvgpr_write_b32 a6, 0
    v_accvgpr_write_b32 a7, 0
    v_accvgpr_write_b32 a8, 0
    v_accvgpr_write_b32 a9, 0
    v_accvgpr_write_b32 a10, 0
    v_accvgpr_write_b32 a11, 0
    v_accvgpr_write_b32 a12, 0
    v_accvgpr_write_b32 a13, 0
    v_accvgpr_write_b32 a14, 0
    v_accvgpr_write_b32 a15, 0
    v_accvgpr_write_b32 a16, 0
    v_accvgpr_write_b32 a17, 0
    v_accvgpr_write_b32 a18, 0
    v_accvgpr_write_b32 a19, 0
    v_accvgpr_write_b32 a20, 0
    v_accvgpr_write_b32 a21, 0
    v_accvgpr_write_b32 a22, 0
    v_accvgpr_write_b32 a23, 0
    v_accvgpr_write_b32 a24, 0
    v_accvgpr_write_b32 a25, 0
    v_accvgpr_write_b32 a26, 0
    v_accvgpr_write_b32 a27, 0
    v_accvgpr_write_b32 a28, 0
    v_accvgpr_write_b32 a29, 0
    v_accvgpr_write_b32 a30, 0
    v_accvgpr_write_b32 a31, 0
    v_accvgpr_write_b32 a32, 0
    v_accvgpr_write_b32 a33, 0
    v_accvgpr_write_b32 a34, 0
    v_accvgpr_write_b32 a35, 0
    v_accvgpr_write_b32 a36, 0
    v_accvgpr_write_b32 a37, 0
    v_accvgpr_write_b32 a38, 0
    v_accvgpr_write_b32 a39, 0
    v_accvgpr_write_b32 a40, 0
    v_accvgpr_write_b32 a41, 0
    v_accvgpr_write_b32 a42, 0
    v_accvgpr_write_b32 a43, 0
    v_accvgpr_write_b32 a44, 0
    v_accvgpr_write_b32 a45, 0
    v_accvgpr_write_b32 a46, 0
    v_accvgpr_write_b32 a47, 0
    v_accvgpr_write_b32 a48, 0
    v_accvgpr_write_b32 a49, 0
    v_accvgpr_write_b32 a50, 0
    v_accvgpr_write_b32 a51, 0
    v_accvgpr_write_b32 a52, 0
    v_accvgpr_write_b32 a53, 0
    v_accvgpr_write_b32 a54, 0
    v_accvgpr_write_b32 a55, 0
    v_accvgpr_write_b32 a56, 0
    v_accvgpr_write_b32 a57, 0
    v_accvgpr_write_b32 a58, 0
    v_accvgpr_write_b32 a59, 0
    v_accvgpr_write_b32 a60, 0
    v_accvgpr_write_b32 a61, 0
    v_accvgpr_write_b32 a62, 0
    v_accvgpr_write_b32 a63, 0
    v_mov_b32 v150, 0
    v_mov_b32 v151, 0
    v_mov_b32 v158, 0
    v_mov_b32 v159, 0
    v_mov_b32 v166, 0
    v_mov_b32 v167, 0
    v_mov_b32 v174, 0
    v_mov_b32 v175, 0
    v_mov_b32 v86, 0x3f803f80
    v_mov_b32 v87, 0x3f80
    v_mov_b32 v94, 0x3f803f80
    v_mov_b32 v95, 0x3f80
    v_mov_b32 v102, 0x3f803f80
    v_mov_b32 v103, 0x3f80
    v_mov_b32 v110, 0x3f803f80
    v_mov_b32 v111, 0x3f80
    v_mov_b32 v10, 138768
    s_mov_b32 s61, 24117248
    s_mov_b32 s68, 100000
parallel_sum__softmax_full_mha__mixer_channel_mlp__prompt_kernel_fq_p_34:
    buffer_load_dwordx2 v[26:27], v12, s[4:7], s61 offen sc1
    buffer_load_dwordx2 v[28:29], v11, s[4:7], s61 offen sc1
    s_sub_u32 s68, s68, 1
    s_cmp_eq_u32 s68, 0
    s_cbranch_scc1 parallel_sum__softmax_full_mha__mixer_channel_mlp__prompt_kernel_fq_g_35
    s_waitcnt vmcnt(0)
    v_cmp_ne_u64 vcc, v[14:15], v[26:27]
    v_cmp_ne_u64 s[66:67], v[14:15], v[28:29]
    s_or_b64 vcc, vcc, s[66:67]
    s_cbranch_vccz parallel_sum__softmax_full_mha__mixer_channel_mlp__prompt_kernel_fq_g_35
    s_sleep 1
    s_branch parallel_sum__softmax_full_mha__mixer_channel_mlp__prompt_kernel_fq_p_34
parallel_sum__softmax_full_mha__mixer_channel_mlp__prompt_kernel_fq_g_35:
    s_mov_b32 s58, 1
    s_lshl_b32 s60, s53, 1
    s_add_u32 s60, s60, 0
    s_and_b32 s60, s60, 3
    s_mul_i32 s60, s60, 1536
    s_add_u32 s66, s60, s55
    s_lshl_b32 s60, s53, 1
    s_add_u32 s60, s60, 1
    s_and_b32 s60, s60, 3
    s_mul_i32 s60, s60, 1536
    s_add_u32 s67, s60, s55
    s_lshl_b32 s60, s53, 1
    s_add_u32 s60, s60, 2
    s_and_b32 s60, s60, 3
    s_mul_i32 s60, s60, 1536
    s_add_u32 s68, s60, s55
    s_lshl_b32 s60, s53, 1
    s_add_u32 s60, s60, 3
    s_and_b32 s60, s60, 3
    s_mul_i32 s60, s60, 1536
    s_add_u32 s69, s60, s55
    buffer_load_dwordx4 v[80:83], v18, s[4:7], s62 offen offset:0 sc1
    buffer_load_dwordx2 v[84:85], v19, s[4:7], s62 offen offset:0 sc1
    buffer_load_dwordx4 v[144:147], v21, s[4:7], s66 offen sc1
    buffer_load_dwordx2 v[148:149], v22, s[4:7], s66 offen sc1
    buffer_load_dwordx4 v[152:155], v21, s[4:7], s67 offen sc1
    buffer_load_dwordx2 v[156:157], v22, s[4:7], s67 offen sc1
    buffer_load_dwordx4 v[112:115], v20, s[4:7], s63 offen offset:0 sc1
    buffer_load_dwordx4 v[116:119], v20, s[4:7], s63 offen offset:1024 sc1
    buffer_load_dwordx4 v[160:163], v21, s[4:7], s68 offen sc1
    buffer_load_dwordx2 v[164:165], v22, s[4:7], s68 offen sc1
    buffer_load_dwordx4 v[168:171], v21, s[4:7], s69 offen sc1
    buffer_load_dwordx2 v[172:173], v22, s[4:7], s69 offen sc1
    s_mov_b32 s61, 24117248
    s_mov_b32 s68, 100000
parallel_sum__softmax_full_mha__mixer_channel_mlp__prompt_kernel_fq2_p_36:
    buffer_load_dwordx2 v[26:27], v9, s[4:7], s61 offen sc1
    s_sub_u32 s68, s68, 1
    s_cmp_eq_u32 s68, 0
    s_cbranch_scc1 parallel_sum__softmax_full_mha__mixer_channel_mlp__prompt_kernel_fq2_g_37
    s_waitcnt vmcnt(0)
    v_cmp_ne_u64 vcc, v[14:15], v[26:27]
    s_cbranch_vccz parallel_sum__softmax_full_mha__mixer_channel_mlp__prompt_kernel_fq2_g_37
    s_sleep 1
    s_branch parallel_sum__softmax_full_mha__mixer_channel_mlp__prompt_kernel_fq2_p_36
parallel_sum__softmax_full_mha__mixer_channel_mlp__prompt_kernel_fq2_g_37:
    s_waitcnt vmcnt(0)
    buffer_load_dwordx4 v[88:91], v18, s[4:7], s62 offen offset:1536 sc1
    buffer_load_dwordx2 v[92:93], v19, s[4:7], s62 offen offset:1536 sc1
    buffer_load_dwordx4 v[120:123], v20, s[4:7], s63 offen offset:2048 sc1
    buffer_load_dwordx4 v[124:127], v20, s[4:7], s63 offen offset:3072 sc1
    s_add_u32 s64, s62, 3072
    s_add_u32 s65, s63, 4096
    buffer_load_dwordx4 v[96:99], v18, s[4:7], s64 offen offset:0 sc1
    buffer_load_dwordx2 v[100:101], v19, s[4:7], s64 offen offset:0 sc1
    buffer_load_dwordx4 v[128:131], v20, s[4:7], s65 offen offset:0 sc1
    buffer_load_dwordx4 v[132:135], v20, s[4:7], s65 offen offset:1024 sc1
    s_waitcnt lgkmcnt(0)
    s_barrier
    s_branch parallel_sum__softmax_full_mha__mixer_channel_mlp__prompt_kernel_first
parallel_sum__softmax_full_mha__mixer_channel_mlp__prompt_kernel_restart:
    v_mov_b32 v86, 0x3f803f80
    v_mov_b32 v87, 0x3f80
    v_mov_b32 v94, 0x3f803f80
    v_mov_b32 v95, 0x3f80
    v_mov_b32 v102, 0x3f803f80
    v_mov_b32 v103, 0x3f80
    v_mov_b32 v110, 0x3f803f80
    v_mov_b32 v111, 0x3f80
    v_accvgpr_write_b32 a0, 0
    v_accvgpr_write_b32 a1, 0
    v_accvgpr_write_b32 a2, 0
    v_accvgpr_write_b32 a3, 0
    v_accvgpr_write_b32 a4, 0
    v_accvgpr_write_b32 a5, 0
    v_accvgpr_write_b32 a6, 0
    v_accvgpr_write_b32 a7, 0
    v_accvgpr_write_b32 a8, 0
    v_accvgpr_write_b32 a9, 0
    v_accvgpr_write_b32 a10, 0
    v_accvgpr_write_b32 a11, 0
    v_accvgpr_write_b32 a12, 0
    v_accvgpr_write_b32 a13, 0
    v_accvgpr_write_b32 a14, 0
    v_accvgpr_write_b32 a15, 0
    v_accvgpr_write_b32 a16, 0
    v_accvgpr_write_b32 a17, 0
    v_accvgpr_write_b32 a18, 0
    v_accvgpr_write_b32 a19, 0
    v_accvgpr_write_b32 a20, 0
    v_accvgpr_write_b32 a21, 0
    v_accvgpr_write_b32 a22, 0
    v_accvgpr_write_b32 a23, 0
    v_accvgpr_write_b32 a24, 0
    v_accvgpr_write_b32 a25, 0
    v_accvgpr_write_b32 a26, 0
    v_accvgpr_write_b32 a27, 0
    v_accvgpr_write_b32 a28, 0
    v_accvgpr_write_b32 a29, 0
    v_accvgpr_write_b32 a30, 0
    v_accvgpr_write_b32 a31, 0
    v_accvgpr_write_b32 a32, 0
    v_accvgpr_write_b32 a33, 0
    v_accvgpr_write_b32 a34, 0
    v_accvgpr_write_b32 a35, 0
    v_accvgpr_write_b32 a36, 0
    v_accvgpr_write_b32 a37, 0
    v_accvgpr_write_b32 a38, 0
    v_accvgpr_write_b32 a39, 0
    v_accvgpr_write_b32 a40, 0
    v_accvgpr_write_b32 a41, 0
    v_accvgpr_write_b32 a42, 0
    v_accvgpr_write_b32 a43, 0
    v_accvgpr_write_b32 a44, 0
    v_accvgpr_write_b32 a45, 0
    v_accvgpr_write_b32 a46, 0
    v_accvgpr_write_b32 a47, 0
    v_accvgpr_write_b32 a48, 0
    v_accvgpr_write_b32 a49, 0
    v_accvgpr_write_b32 a50, 0
    v_accvgpr_write_b32 a51, 0
    v_accvgpr_write_b32 a52, 0
    v_accvgpr_write_b32 a53, 0
    v_accvgpr_write_b32 a54, 0
    v_accvgpr_write_b32 a55, 0
    v_accvgpr_write_b32 a56, 0
    v_accvgpr_write_b32 a57, 0
    v_accvgpr_write_b32 a58, 0
    v_accvgpr_write_b32 a59, 0
    v_accvgpr_write_b32 a60, 0
    v_accvgpr_write_b32 a61, 0
    v_accvgpr_write_b32 a62, 0
    v_accvgpr_write_b32 a63, 0
    v_mov_b32 v24, 0xff800000
    v_mov_b32 v25, 0xff800000
    s_mov_b32 s60, s54
    s_mov_b32 s61, s58
    s_lshl_b32 s64, s52, 12
    s_lshl_b32 s65, s53, 10
    s_add_u32 s64, s64, s65
    s_add_u32 s64, s64, 102400
    v_lshl_add_u32 v8, v1, 3, s64
parallel_sum__softmax_full_mha__mixer_channel_mlp__prompt_kernel_mx:
    buffer_load_dwordx4 v[104:107], v18, s[4:7], s60 offen offset:0 sc1
    buffer_load_dwordx2 v[108:109], v19, s[4:7], s60 offen offset:0 sc1
    s_waitcnt vmcnt(0)
    v_mfma_f32_32x32x16_bf16 v[32:47], v[104:107], v[144:147], 0
    v_mfma_f32_32x32x16_bf16 v[32:47], v[108:111], v[148:151], v[32:47]
    v_mfma_f32_32x32x16_bf16 v[48:63], v[104:107], v[152:155], 0
    v_mfma_f32_32x32x16_bf16 v[48:63], v[108:111], v[156:159], v[48:63]
    s_nop 7
    s_add_u32 s60, s60, 1536
    s_sub_u32 s61, s61, 1
    v_max3_f32 v24, v32, v33, v24
    v_max3_f32 v24, v34, v35, v24
    v_max3_f32 v24, v36, v37, v24
    v_max3_f32 v24, v38, v39, v24
    v_max3_f32 v24, v40, v41, v24
    v_max3_f32 v24, v42, v43, v24
    v_max3_f32 v24, v44, v45, v24
    v_max3_f32 v24, v46, v47, v24
    v_max3_f32 v25, v48, v49, v25
    v_max3_f32 v25, v50, v51, v25
    v_max3_f32 v25, v52, v53, v25
    v_max3_f32 v25, v54, v55, v25
    v_max3_f32 v25, v56, v57, v25
    v_max3_f32 v25, v58, v59, v25
    v_max3_f32 v25, v60, v61, v25
    v_max3_f32 v25, v62, v63, v25
    s_cmp_lg_u32 s61, 0
    s_cbranch_scc1 parallel_sum__softmax_full_mha__mixer_channel_mlp__prompt_kernel_mx
    v_mov_b32 v6, v24
    v_mov_b32 v7, v24
    s_nop 1
    v_permlane32_swap_b32 v6, v7
    s_nop 1
    v_max_f32 v24, v6, v7
    v_sub_f32 v24, 0, v24
    v_and_b32 v6, 0xffff0000, v24
    v_sub_f32 v24, v24, v6
    v_and_b32 v7, 0xffff0000, v24
    v_sub_f32 v24, v24, v7
    v_lshrrev_b32 v6, 16, v6
    v_or_b32 v6, v6, v7
    v_lshrrev_b32 v7, 16, v24
    v_cndmask_b32 v26, 0, v6, s[56:57]
    v_cndmask_b32 v27, 0, v7, s[56:57]
    ds_write_b64 v8, v[26:27] offset:0
    ds_write_b64 v8, v[26:27] offset:2048
    v_mov_b32 v6, v25
    v_mov_b32 v7, v25
    s_nop 1
    v_permlane32_swap_b32 v6, v7
    s_nop 1
    v_max_f32 v25, v6, v7
    v_sub_f32 v25, 0, v25
    v_and_b32 v6, 0xffff0000, v25
    v_sub_f32 v25, v25, v6
    v_and_b32 v7, 0xffff0000, v25
    v_sub_f32 v25, v25, v7
    v_lshrrev_b32 v6, 16, v6
    v_or_b32 v6, v6, v7
    v_lshrrev_b32 v7, 16, v25
    v_cndmask_b32 v26, 0, v6, s[56:57]
    v_cndmask_b32 v27, 0, v7, s[56:57]
    ds_write_b64 v8, v[26:27] offset:512
    ds_write_b64 v8, v[26:27] offset:2560
    buffer_load_dwordx4 v[80:83], v18, s[4:7], s62 offen offset:0 sc1
    buffer_load_dwordx2 v[84:85], v19, s[4:7], s62 offen offset:0 sc1
    buffer_load_dwordx4 v[112:115], v20, s[4:7], s63 offen offset:0 sc1
    buffer_load_dwordx4 v[116:119], v20, s[4:7], s63 offen offset:1024 sc1
    buffer_load_dwordx4 v[88:91], v18, s[4:7], s62 offen offset:1536 sc1
    buffer_load_dwordx2 v[92:93], v19, s[4:7], s62 offen offset:1536 sc1
    buffer_load_dwordx4 v[120:123], v20, s[4:7], s63 offen offset:2048 sc1
    buffer_load_dwordx4 v[124:127], v20, s[4:7], s63 offen offset:3072 sc1
    s_add_u32 s64, s62, 3072
    s_add_u32 s65, s63, 4096
    buffer_load_dwordx4 v[96:99], v18, s[4:7], s64 offen offset:0 sc1
    buffer_load_dwordx2 v[100:101], v19, s[4:7], s64 offen offset:0 sc1
    buffer_load_dwordx4 v[128:131], v20, s[4:7], s65 offen offset:0 sc1
    buffer_load_dwordx4 v[132:135], v20, s[4:7], s65 offen offset:1024 sc1
    s_waitcnt lgkmcnt(0)
    s_barrier
    ds_read_b64 v[150:151], v8 offset:0
    ds_read_b64 v[158:159], v8 offset:512
    ds_read_b64 v[166:167], v8 offset:1024
    ds_read_b64 v[174:175], v8 offset:1536
    s_waitcnt vmcnt(8) lgkmcnt(0)
parallel_sum__softmax_full_mha__mixer_channel_mlp__prompt_kernel_first:
    v_mov_b32 v140, 0
    v_mov_b32 v76, 0
    v_mov_b32 v141, 0
    v_mov_b32 v77, 0
    v_mov_b32 v142, 0
    v_mov_b32 v78, 0
    v_mov_b32 v143, 0
    v_mov_b32 v79, 0
    v_mfma_f32_32x32x16_bf16 v[32:47], v[80:83], v[144:147], 0
    v_mfma_f32_32x32x16_bf16 v[32:47], v[84:87], v[148:151], v[32:47]
    s_add_u32 s64, s62, 4608
    s_add_u32 s65, s63, 6144
    s_mov_b32 s60, 0
    s_nop 6
.p2align 6
parallel_sum__softmax_full_mha__mixer_channel_mlp__prompt_kernel_loop:
    v_mfma_f32_32x32x16_bf16 v[48:63], v[80:83], v[152:155], 0
    v_exp_f32 v32, v32
    v_exp_f32 v33, v33
    v_exp_f32 v34, v34
    v_exp_f32 v35, v35
    v_mfma_f32_32x32x16_bf16 v[48:63], v[84:87], v[156:159], v[48:63]
    v_exp_f32 v36, v36
    v_exp_f32 v37, v37
    v_exp_f32 v38, v38
    v_exp_f32 v39, v39
    v_mfma_f32_32x32x16_bf16 a[48:63], v[140:143], v[76:79], a[48:63]
    buffer_load_dwordx4 v[104:107], v18, s[4:7], s64 offen offset:0
    buffer_load_dwordx2 v[108:109], v19, s[4:7], s64 offen offset:0
    v_cvt_pk_bf16_f32 v64, v32, v33
    v_cvt_pk_bf16_f32 v65, v34, v35
    v_cvt_pk_bf16_f32 v66, v36, v37
    v_cvt_pk_bf16_f32 v67, v38, v39
    v_exp_f32 v40, v40
    v_exp_f32 v41, v41
    v_exp_f32 v42, v42
    v_exp_f32 v43, v43
    v_mfma_f32_32x32x16_bf16 a[0:15], v[112:115], v[64:67], a[0:15]
    buffer_load_dwordx4 v[136:139], v20, s[4:7], s65 offen offset:0
    buffer_load_dwordx4 v[140:143], v20, s[4:7], s65 offen offset:1024
    v_exp_f32 v44, v44
    v_exp_f32 v45, v45
    v_exp_f32 v46, v46
    v_exp_f32 v47, v47
    v_cvt_pk_bf16_f32 v68, v40, v41
    v_cvt_pk_bf16_f32 v69, v42, v43
    v_cvt_pk_bf16_f32 v70, v44, v45
    v_cvt_pk_bf16_f32 v71, v46, v47
    s_waitcnt vmcnt(12)
    v_mfma_f32_32x32x16_bf16 v[32:47], v[80:83], v[160:163], 0
    v_exp_f32 v48, v48
    v_exp_f32 v49, v49
    v_exp_f32 v50, v50
    v_exp_f32 v51, v51
    v_mfma_f32_32x32x16_bf16 v[32:47], v[84:87], v[164:167], v[32:47]
    v_exp_f32 v52, v52
    v_exp_f32 v53, v53
    v_exp_f32 v54, v54
    v_exp_f32 v55, v55
    v_mfma_f32_32x32x16_bf16 a[0:15], v[116:119], v[68:71], a[0:15]
    s_cmp_eq_u32 s60, 7
    s_cselect_b32 s64, s62, s64
    v_cvt_pk_bf16_f32 v72, v48, v49
    v_cvt_pk_bf16_f32 v73, v50, v51
    v_cvt_pk_bf16_f32 v74, v52, v53
    v_cvt_pk_bf16_f32 v75, v54, v55
    v_exp_f32 v56, v56
    v_exp_f32 v57, v57
    v_exp_f32 v58, v58
    v_exp_f32 v59, v59
    v_mfma_f32_32x32x16_bf16 a[16:31], v[112:115], v[72:75], a[16:31]
    s_cselect_b32 s65, s63, s65
    v_exp_f32 v60, v60
    v_exp_f32 v61, v61
    v_exp_f32 v62, v62
    v_exp_f32 v63, v63
    v_cvt_pk_bf16_f32 v76, v56, v57
    v_cvt_pk_bf16_f32 v77, v58, v59
    v_cvt_pk_bf16_f32 v78, v60, v61
    v_cvt_pk_bf16_f32 v79, v62, v63
    v_mfma_f32_32x32x16_bf16 v[48:63], v[80:83], v[168:171], 0
    v_exp_f32 v32, v32
    v_exp_f32 v33, v33
    v_exp_f32 v34, v34
    v_exp_f32 v35, v35
    v_mfma_f32_32x32x16_bf16 v[48:63], v[84:87], v[172:175], v[48:63]
    v_exp_f32 v36, v36
    v_exp_f32 v37, v37
    v_exp_f32 v38, v38
    v_exp_f32 v39, v39
    v_mfma_f32_32x32x16_bf16 a[16:31], v[116:119], v[76:79], a[16:31]
    v_cvt_pk_bf16_f32 v64, v32, v33
    v_cvt_pk_bf16_f32 v65, v34, v35
    v_cvt_pk_bf16_f32 v66, v36, v37
    v_cvt_pk_bf16_f32 v67, v38, v39
    v_exp_f32 v40, v40
    v_exp_f32 v41, v41
    v_exp_f32 v42, v42
    v_exp_f32 v43, v43
    v_mfma_f32_32x32x16_bf16 a[32:47], v[112:115], v[64:67], a[32:47]
    v_exp_f32 v44, v44
    v_exp_f32 v45, v45
    v_exp_f32 v46, v46
    v_exp_f32 v47, v47
    v_cvt_pk_bf16_f32 v68, v40, v41
    v_cvt_pk_bf16_f32 v69, v42, v43
    v_cvt_pk_bf16_f32 v70, v44, v45
    v_cvt_pk_bf16_f32 v71, v46, v47
    s_waitcnt vmcnt(8)
    v_mfma_f32_32x32x16_bf16 v[32:47], v[88:91], v[144:147], 0
    v_exp_f32 v48, v48
    v_exp_f32 v49, v49
    v_exp_f32 v50, v50
    v_exp_f32 v51, v51
    v_mfma_f32_32x32x16_bf16 v[32:47], v[92:95], v[148:151], v[32:47]
    v_exp_f32 v52, v52
    v_exp_f32 v53, v53
    v_exp_f32 v54, v54
    v_exp_f32 v55, v55
    v_mfma_f32_32x32x16_bf16 a[32:47], v[116:119], v[68:71], a[32:47]
    v_cvt_pk_bf16_f32 v72, v48, v49
    v_cvt_pk_bf16_f32 v73, v50, v51
    v_cvt_pk_bf16_f32 v74, v52, v53
    v_cvt_pk_bf16_f32 v75, v54, v55
    v_exp_f32 v56, v56
    v_exp_f32 v57, v57
    v_exp_f32 v58, v58
    v_exp_f32 v59, v59
    v_mfma_f32_32x32x16_bf16 a[48:63], v[112:115], v[72:75], a[48:63]
    v_exp_f32 v60, v60
    v_exp_f32 v61, v61
    v_exp_f32 v62, v62
    v_exp_f32 v63, v63
    v_cvt_pk_bf16_f32 v76, v56, v57
    v_cvt_pk_bf16_f32 v77, v58, v59
    v_cvt_pk_bf16_f32 v78, v60, v61
    v_cvt_pk_bf16_f32 v79, v62, v63
    v_mfma_f32_32x32x16_bf16 v[48:63], v[88:91], v[152:155], 0
    v_exp_f32 v32, v32
    v_exp_f32 v33, v33
    v_exp_f32 v34, v34
    v_exp_f32 v35, v35
    v_mfma_f32_32x32x16_bf16 v[48:63], v[92:95], v[156:159], v[48:63]
    v_exp_f32 v36, v36
    v_exp_f32 v37, v37
    v_exp_f32 v38, v38
    v_exp_f32 v39, v39
    v_mfma_f32_32x32x16_bf16 a[48:63], v[116:119], v[76:79], a[48:63]
    buffer_load_dwordx4 v[80:83], v18, s[4:7], s64 offen offset:1536
    buffer_load_dwordx2 v[84:85], v19, s[4:7], s64 offen offset:1536
    v_cvt_pk_bf16_f32 v64, v32, v33
    v_cvt_pk_bf16_f32 v65, v34, v35
    v_cvt_pk_bf16_f32 v66, v36, v37
    v_cvt_pk_bf16_f32 v67, v38, v39
    v_exp_f32 v40, v40
    v_exp_f32 v41, v41
    v_exp_f32 v42, v42
    v_exp_f32 v43, v43
    v_mfma_f32_32x32x16_bf16 a[0:15], v[120:123], v[64:67], a[0:15]
    buffer_load_dwordx4 v[112:115], v20, s[4:7], s65 offen offset:2048
    buffer_load_dwordx4 v[116:119], v20, s[4:7], s65 offen offset:3072
    v_exp_f32 v44, v44
    v_exp_f32 v45, v45
    v_exp_f32 v46, v46
    v_exp_f32 v47, v47
    v_cvt_pk_bf16_f32 v68, v40, v41
    v_cvt_pk_bf16_f32 v69, v42, v43
    v_cvt_pk_bf16_f32 v70, v44, v45
    v_cvt_pk_bf16_f32 v71, v46, v47
    v_mfma_f32_32x32x16_bf16 v[32:47], v[88:91], v[160:163], 0
    v_exp_f32 v48, v48
    v_exp_f32 v49, v49
    v_exp_f32 v50, v50
    v_exp_f32 v51, v51
    v_mfma_f32_32x32x16_bf16 v[32:47], v[92:95], v[164:167], v[32:47]
    v_exp_f32 v52, v52
    v_exp_f32 v53, v53
    v_exp_f32 v54, v54
    v_exp_f32 v55, v55
    v_mfma_f32_32x32x16_bf16 a[0:15], v[124:127], v[68:71], a[0:15]
    s_add_u32 s64, s64, 3072
    v_cvt_pk_bf16_f32 v72, v48, v49
    v_cvt_pk_bf16_f32 v73, v50, v51
    v_cvt_pk_bf16_f32 v74, v52, v53
    v_cvt_pk_bf16_f32 v75, v54, v55
    v_exp_f32 v56, v56
    v_exp_f32 v57, v57
    v_exp_f32 v58, v58
    v_exp_f32 v59, v59
    v_mfma_f32_32x32x16_bf16 a[16:31], v[120:123], v[72:75], a[16:31]
    s_add_u32 s65, s65, 4096
    v_exp_f32 v60, v60
    v_exp_f32 v61, v61
    v_exp_f32 v62, v62
    v_exp_f32 v63, v63
    v_cvt_pk_bf16_f32 v76, v56, v57
    v_cvt_pk_bf16_f32 v77, v58, v59
    v_cvt_pk_bf16_f32 v78, v60, v61
    v_cvt_pk_bf16_f32 v79, v62, v63
    v_mfma_f32_32x32x16_bf16 v[48:63], v[88:91], v[168:171], 0
    v_exp_f32 v32, v32
    v_exp_f32 v33, v33
    v_exp_f32 v34, v34
    v_exp_f32 v35, v35
    v_mfma_f32_32x32x16_bf16 v[48:63], v[92:95], v[172:175], v[48:63]
    v_exp_f32 v36, v36
    v_exp_f32 v37, v37
    v_exp_f32 v38, v38
    v_exp_f32 v39, v39
    v_mfma_f32_32x32x16_bf16 a[16:31], v[124:127], v[76:79], a[16:31]
    v_cvt_pk_bf16_f32 v64, v32, v33
    v_cvt_pk_bf16_f32 v65, v34, v35
    v_cvt_pk_bf16_f32 v66, v36, v37
    v_cvt_pk_bf16_f32 v67, v38, v39
    v_exp_f32 v40, v40
    v_exp_f32 v41, v41
    v_exp_f32 v42, v42
    v_exp_f32 v43, v43
    v_mfma_f32_32x32x16_bf16 a[32:47], v[120:123], v[64:67], a[32:47]
    v_exp_f32 v44, v44
    v_exp_f32 v45, v45
    v_exp_f32 v46, v46
    v_exp_f32 v47, v47
    v_cvt_pk_bf16_f32 v68, v40, v41
    v_cvt_pk_bf16_f32 v69, v42, v43
    v_cvt_pk_bf16_f32 v70, v44, v45
    v_cvt_pk_bf16_f32 v71, v46, v47
    s_waitcnt vmcnt(8)
    v_mfma_f32_32x32x16_bf16 v[32:47], v[96:99], v[144:147], 0
    v_exp_f32 v48, v48
    v_exp_f32 v49, v49
    v_exp_f32 v50, v50
    v_exp_f32 v51, v51
    v_mfma_f32_32x32x16_bf16 v[32:47], v[100:103], v[148:151], v[32:47]
    v_exp_f32 v52, v52
    v_exp_f32 v53, v53
    v_exp_f32 v54, v54
    v_exp_f32 v55, v55
    v_mfma_f32_32x32x16_bf16 a[32:47], v[124:127], v[68:71], a[32:47]
    v_cvt_pk_bf16_f32 v72, v48, v49
    v_cvt_pk_bf16_f32 v73, v50, v51
    v_cvt_pk_bf16_f32 v74, v52, v53
    v_cvt_pk_bf16_f32 v75, v54, v55
    v_exp_f32 v56, v56
    v_exp_f32 v57, v57
    v_exp_f32 v58, v58
    v_exp_f32 v59, v59
    v_mfma_f32_32x32x16_bf16 a[48:63], v[120:123], v[72:75], a[48:63]
    v_exp_f32 v60, v60
    v_exp_f32 v61, v61
    v_exp_f32 v62, v62
    v_exp_f32 v63, v63
    v_cvt_pk_bf16_f32 v76, v56, v57
    v_cvt_pk_bf16_f32 v77, v58, v59
    v_cvt_pk_bf16_f32 v78, v60, v61
    v_cvt_pk_bf16_f32 v79, v62, v63
    v_mfma_f32_32x32x16_bf16 v[48:63], v[96:99], v[152:155], 0
    v_exp_f32 v32, v32
    v_exp_f32 v33, v33
    v_exp_f32 v34, v34
    v_exp_f32 v35, v35
    v_mfma_f32_32x32x16_bf16 v[48:63], v[100:103], v[156:159], v[48:63]
    v_exp_f32 v36, v36
    v_exp_f32 v37, v37
    v_exp_f32 v38, v38
    v_exp_f32 v39, v39
    v_mfma_f32_32x32x16_bf16 a[48:63], v[124:127], v[76:79], a[48:63]
    buffer_load_dwordx4 v[88:91], v18, s[4:7], s64 offen offset:0
    buffer_load_dwordx2 v[92:93], v19, s[4:7], s64 offen offset:0
    v_cvt_pk_bf16_f32 v64, v32, v33
    v_cvt_pk_bf16_f32 v65, v34, v35
    v_cvt_pk_bf16_f32 v66, v36, v37
    v_cvt_pk_bf16_f32 v67, v38, v39
    v_exp_f32 v40, v40
    v_exp_f32 v41, v41
    v_exp_f32 v42, v42
    v_exp_f32 v43, v43
    v_mfma_f32_32x32x16_bf16 a[0:15], v[128:131], v[64:67], a[0:15]
    buffer_load_dwordx4 v[120:123], v20, s[4:7], s65 offen offset:0
    buffer_load_dwordx4 v[124:127], v20, s[4:7], s65 offen offset:1024
    v_exp_f32 v44, v44
    v_exp_f32 v45, v45
    v_exp_f32 v46, v46
    v_exp_f32 v47, v47
    v_cvt_pk_bf16_f32 v68, v40, v41
    v_cvt_pk_bf16_f32 v69, v42, v43
    v_cvt_pk_bf16_f32 v70, v44, v45
    v_cvt_pk_bf16_f32 v71, v46, v47
    v_mfma_f32_32x32x16_bf16 v[32:47], v[96:99], v[160:163], 0
    v_exp_f32 v48, v48
    v_exp_f32 v49, v49
    v_exp_f32 v50, v50
    v_exp_f32 v51, v51
    v_mfma_f32_32x32x16_bf16 v[32:47], v[100:103], v[164:167], v[32:47]
    v_exp_f32 v52, v52
    v_exp_f32 v53, v53
    v_exp_f32 v54, v54
    v_exp_f32 v55, v55
    v_mfma_f32_32x32x16_bf16 a[0:15], v[132:135], v[68:71], a[0:15]
    v_cvt_pk_bf16_f32 v72, v48, v49
    v_cvt_pk_bf16_f32 v73, v50, v51
    v_cvt_pk_bf16_f32 v74, v52, v53
    v_cvt_pk_bf16_f32 v75, v54, v55
    v_exp_f32 v56, v56
    v_exp_f32 v57, v57
    v_exp_f32 v58, v58
    v_exp_f32 v59, v59
    v_mfma_f32_32x32x16_bf16 a[16:31], v[128:131], v[72:75], a[16:31]
    v_exp_f32 v60, v60
    v_exp_f32 v61, v61
    v_exp_f32 v62, v62
    v_exp_f32 v63, v63
    v_cvt_pk_bf16_f32 v76, v56, v57
    v_cvt_pk_bf16_f32 v77, v58, v59
    v_cvt_pk_bf16_f32 v78, v60, v61
    v_cvt_pk_bf16_f32 v79, v62, v63
    v_mfma_f32_32x32x16_bf16 v[48:63], v[96:99], v[168:171], 0
    v_exp_f32 v32, v32
    v_exp_f32 v33, v33
    v_exp_f32 v34, v34
    v_exp_f32 v35, v35
    v_mfma_f32_32x32x16_bf16 v[48:63], v[100:103], v[172:175], v[48:63]
    v_exp_f32 v36, v36
    v_exp_f32 v37, v37
    v_exp_f32 v38, v38
    v_exp_f32 v39, v39
    v_mfma_f32_32x32x16_bf16 a[16:31], v[132:135], v[76:79], a[16:31]
    v_cvt_pk_bf16_f32 v64, v32, v33
    v_cvt_pk_bf16_f32 v65, v34, v35
    v_cvt_pk_bf16_f32 v66, v36, v37
    v_cvt_pk_bf16_f32 v67, v38, v39
    v_exp_f32 v40, v40
    v_exp_f32 v41, v41
    v_exp_f32 v42, v42
    v_exp_f32 v43, v43
    v_mfma_f32_32x32x16_bf16 a[32:47], v[128:131], v[64:67], a[32:47]
    v_exp_f32 v44, v44
    v_exp_f32 v45, v45
    v_exp_f32 v46, v46
    v_exp_f32 v47, v47
    v_cvt_pk_bf16_f32 v68, v40, v41
    v_cvt_pk_bf16_f32 v69, v42, v43
    v_cvt_pk_bf16_f32 v70, v44, v45
    v_cvt_pk_bf16_f32 v71, v46, v47
    s_waitcnt vmcnt(8)
    v_mfma_f32_32x32x16_bf16 v[32:47], v[104:107], v[144:147], 0
    v_exp_f32 v48, v48
    v_exp_f32 v49, v49
    v_exp_f32 v50, v50
    v_exp_f32 v51, v51
    v_mfma_f32_32x32x16_bf16 v[32:47], v[108:111], v[148:151], v[32:47]
    v_exp_f32 v52, v52
    v_exp_f32 v53, v53
    v_exp_f32 v54, v54
    v_exp_f32 v55, v55
    v_mfma_f32_32x32x16_bf16 a[32:47], v[132:135], v[68:71], a[32:47]
    v_cvt_pk_bf16_f32 v72, v48, v49
    v_cvt_pk_bf16_f32 v73, v50, v51
    v_cvt_pk_bf16_f32 v74, v52, v53
    v_cvt_pk_bf16_f32 v75, v54, v55
    v_exp_f32 v56, v56
    v_exp_f32 v57, v57
    v_exp_f32 v58, v58
    v_exp_f32 v59, v59
    v_mfma_f32_32x32x16_bf16 a[48:63], v[128:131], v[72:75], a[48:63]
    v_exp_f32 v60, v60
    v_exp_f32 v61, v61
    v_exp_f32 v62, v62
    v_exp_f32 v63, v63
    v_cvt_pk_bf16_f32 v76, v56, v57
    v_cvt_pk_bf16_f32 v77, v58, v59
    v_cvt_pk_bf16_f32 v78, v60, v61
    v_cvt_pk_bf16_f32 v79, v62, v63
    v_mfma_f32_32x32x16_bf16 v[48:63], v[104:107], v[152:155], 0
    v_exp_f32 v32, v32
    v_exp_f32 v33, v33
    v_exp_f32 v34, v34
    v_exp_f32 v35, v35
    v_mfma_f32_32x32x16_bf16 v[48:63], v[108:111], v[156:159], v[48:63]
    v_exp_f32 v36, v36
    v_exp_f32 v37, v37
    v_exp_f32 v38, v38
    v_exp_f32 v39, v39
    v_mfma_f32_32x32x16_bf16 a[48:63], v[132:135], v[76:79], a[48:63]
    buffer_load_dwordx4 v[96:99], v18, s[4:7], s64 offen offset:1536
    buffer_load_dwordx2 v[100:101], v19, s[4:7], s64 offen offset:1536
    v_cvt_pk_bf16_f32 v64, v32, v33
    v_cvt_pk_bf16_f32 v65, v34, v35
    v_cvt_pk_bf16_f32 v66, v36, v37
    v_cvt_pk_bf16_f32 v67, v38, v39
    v_exp_f32 v40, v40
    v_exp_f32 v41, v41
    v_exp_f32 v42, v42
    v_exp_f32 v43, v43
    v_mfma_f32_32x32x16_bf16 a[0:15], v[136:139], v[64:67], a[0:15]
    buffer_load_dwordx4 v[128:131], v20, s[4:7], s65 offen offset:2048
    buffer_load_dwordx4 v[132:135], v20, s[4:7], s65 offen offset:3072
    v_exp_f32 v44, v44
    v_exp_f32 v45, v45
    v_exp_f32 v46, v46
    v_exp_f32 v47, v47
    v_cvt_pk_bf16_f32 v68, v40, v41
    v_cvt_pk_bf16_f32 v69, v42, v43
    v_cvt_pk_bf16_f32 v70, v44, v45
    v_cvt_pk_bf16_f32 v71, v46, v47
    v_mfma_f32_32x32x16_bf16 v[32:47], v[104:107], v[160:163], 0
    v_exp_f32 v48, v48
    v_exp_f32 v49, v49
    v_exp_f32 v50, v50
    v_exp_f32 v51, v51
    v_mfma_f32_32x32x16_bf16 v[32:47], v[108:111], v[164:167], v[32:47]
    v_exp_f32 v52, v52
    v_exp_f32 v53, v53
    v_exp_f32 v54, v54
    v_exp_f32 v55, v55
    v_mfma_f32_32x32x16_bf16 a[0:15], v[140:143], v[68:71], a[0:15]
    s_add_u32 s64, s64, 3072
    v_cvt_pk_bf16_f32 v72, v48, v49
    v_cvt_pk_bf16_f32 v73, v50, v51
    v_cvt_pk_bf16_f32 v74, v52, v53
    v_cvt_pk_bf16_f32 v75, v54, v55
    v_exp_f32 v56, v56
    v_exp_f32 v57, v57
    v_exp_f32 v58, v58
    v_exp_f32 v59, v59
    v_mfma_f32_32x32x16_bf16 a[16:31], v[136:139], v[72:75], a[16:31]
    s_add_u32 s65, s65, 4096
    v_exp_f32 v60, v60
    v_exp_f32 v61, v61
    v_exp_f32 v62, v62
    v_exp_f32 v63, v63
    v_cvt_pk_bf16_f32 v76, v56, v57
    v_cvt_pk_bf16_f32 v77, v58, v59
    v_cvt_pk_bf16_f32 v78, v60, v61
    v_cvt_pk_bf16_f32 v79, v62, v63
    v_mfma_f32_32x32x16_bf16 v[48:63], v[104:107], v[168:171], 0
    v_exp_f32 v32, v32
    v_exp_f32 v33, v33
    v_exp_f32 v34, v34
    v_exp_f32 v35, v35
    v_mfma_f32_32x32x16_bf16 v[48:63], v[108:111], v[172:175], v[48:63]
    v_exp_f32 v36, v36
    v_exp_f32 v37, v37
    v_exp_f32 v38, v38
    v_exp_f32 v39, v39
    v_mfma_f32_32x32x16_bf16 a[16:31], v[140:143], v[76:79], a[16:31]
    s_add_u32 s60, s60, 1
    v_cvt_pk_bf16_f32 v64, v32, v33
    v_cvt_pk_bf16_f32 v65, v34, v35
    v_cvt_pk_bf16_f32 v66, v36, v37
    v_cvt_pk_bf16_f32 v67, v38, v39
    v_exp_f32 v40, v40
    v_exp_f32 v41, v41
    v_exp_f32 v42, v42
    v_exp_f32 v43, v43
    v_mfma_f32_32x32x16_bf16 a[32:47], v[136:139], v[64:67], a[32:47]
    s_cmp_lt_u32 s60, 8
    v_exp_f32 v44, v44
    v_exp_f32 v45, v45
    v_exp_f32 v46, v46
    v_exp_f32 v47, v47
    v_cvt_pk_bf16_f32 v68, v40, v41
    v_cvt_pk_bf16_f32 v69, v42, v43
    v_cvt_pk_bf16_f32 v70, v44, v45
    v_cvt_pk_bf16_f32 v71, v46, v47
    s_waitcnt vmcnt(8)
    v_mfma_f32_32x32x16_bf16 v[32:47], v[80:83], v[144:147], 0
    v_exp_f32 v48, v48
    v_exp_f32 v49, v49
    v_exp_f32 v50, v50
    v_exp_f32 v51, v51
    v_mfma_f32_32x32x16_bf16 v[32:47], v[84:87], v[148:151], v[32:47]
    v_exp_f32 v52, v52
    v_exp_f32 v53, v53
    v_exp_f32 v54, v54
    v_exp_f32 v55, v55
    v_mfma_f32_32x32x16_bf16 a[32:47], v[140:143], v[68:71], a[32:47]
    v_cvt_pk_bf16_f32 v72, v48, v49
    v_cvt_pk_bf16_f32 v73, v50, v51
    v_cvt_pk_bf16_f32 v74, v52, v53
    v_cvt_pk_bf16_f32 v75, v54, v55
    v_exp_f32 v56, v56
    v_exp_f32 v57, v57
    v_exp_f32 v58, v58
    v_exp_f32 v59, v59
    v_mfma_f32_32x32x16_bf16 a[48:63], v[136:139], v[72:75], a[48:63]
    v_exp_f32 v60, v60
    v_exp_f32 v61, v61
    v_exp_f32 v62, v62
    v_exp_f32 v63, v63
    v_cvt_pk_bf16_f32 v76, v56, v57
    v_cvt_pk_bf16_f32 v77, v58, v59
    v_cvt_pk_bf16_f32 v78, v60, v61
    v_cvt_pk_bf16_f32 v79, v62, v63
    s_cbranch_scc1 parallel_sum__softmax_full_mha__mixer_channel_mlp__prompt_kernel_loop
    s_nop 1
    v_mfma_f32_32x32x16_bf16 a[48:63], v[140:143], v[76:79], a[48:63]
    s_xor_b32 s60, s3, 2
    s_mul_i32 s60, s60, 6144
    s_add_u32 s60, s60, 110592
    v_add_u32 v4, s60, v17
    s_mul_i32 s60, s3, 6144
    s_add_u32 s60, s60, 110592
    v_add_u32 v7, s60, v17
    s_mov_b32 s60, 0x5d800000
    s_nop 3
    ds_write_b128 v4, a[32:35] offset:0
    ds_write_b128 v4, a[36:39] offset:1024
    ds_write_b128 v4, a[40:43] offset:2048
    v_accvgpr_read_b32 v32, a8
    v_accvgpr_read_b32 v33, a24
    v_accvgpr_read_b32 v34, a40
    v_accvgpr_read_b32 v35, a56
    ds_write_b128 v4, a[48:51] offset:3072
    ds_write_b128 v4, a[52:55] offset:4096
    ds_write_b128 v4, a[56:59] offset:5120
    v_min_f32 v36, v32, v33
    v_min3_f32 v36, v36, v34, v35
    v_add_f32 v32, v32, v33
    v_add_f32 v32, v32, v34
    v_add_f32 v32, v32, v35
    s_mov_b32 s61, 0x21800000
    v_cmp_nge_f32 vcc, s60, v32
    v_cmp_nle_f32 s[66:67], s61, v36
    s_or_b64 vcc, vcc, s[66:67]
    s_andn2_b64 vcc, vcc, s[56:57]
    s_cbranch_vccz parallel_sum__softmax_full_mha__mixer_channel_mlp__prompt_kernel_notbad
    v_mov_b32 v11, 1
    ds_write_b32 v10, v11
parallel_sum__softmax_full_mha__mixer_channel_mlp__prompt_kernel_notbad:
    s_lshl_b32 s60, s49, 3
    s_lshl_b32 s61, s52, 2
    s_add_u32 s60, s60, s61
    s_lshl_b32 s61, s53, 1
    s_add_u32 s60, s60, s61
    s_lshr_b32 s66, s60, 1
    s_mul_i32 s60, s60, 40960
    s_add_u32 s60, s60, 16777216
    s_lshl_b32 s64, s48, 10
    s_add_u32 s64, s64, s60
    s_lshr_b32 s65, s48, 2
    s_add_u32 s65, s65, 32
    s_lshl_b32 s65, s65, 10
    s_add_u32 s65, s65, s60
    s_bfe_u32 s60, s48, 0x10001
    s_lshl_b32 s60, s60, 9
    s_add_u32 s65, s65, s60
    s_and_b32 s60, s48, 1
    s_lshl_b32 s60, s60, 3
    s_add_u32 s65, s65, s60
    s_lshl_b32 s66, s66, 8
    s_lshl_b32 s60, s48, 3
    s_add_u32 s66, s66, s60
    s_add_u32 s66, s66, 24141824
    s_waitcnt vmcnt(0)
    v_accvgpr_read_b32 v64, a0
    v_accvgpr_read_b32 v65, a1
    v_accvgpr_read_b32 v66, a2
    v_accvgpr_read_b32 v67, a3
    v_accvgpr_read_b32 v68, a4
    v_accvgpr_read_b32 v69, a5
    v_accvgpr_read_b32 v70, a6
    v_accvgpr_read_b32 v71, a7
    v_accvgpr_read_b32 v72, a8
    v_accvgpr_read_b32 v73, a9
    v_accvgpr_read_b32 v74, a10
    v_accvgpr_read_b32 v75, a11
    v_accvgpr_read_b32 v76, a16
    v_accvgpr_read_b32 v77, a17
    v_accvgpr_read_b32 v78, a18
    v_accvgpr_read_b32 v79, a19
    v_accvgpr_read_b32 v80, a20
    v_accvgpr_read_b32 v81, a21
    v_accvgpr_read_b32 v82, a22
    v_accvgpr_read_b32 v83, a23
    v_accvgpr_read_b32 v84, a24
    v_accvgpr_read_b32 v85, a25
    v_accvgpr_read_b32 v86, a26
    v_accvgpr_read_b32 v87, a27
    s_waitcnt lgkmcnt(0)
    s_barrier
    ds_read_b32 v11, v10
    ds_read_b128 v[32:35], v7 offset:0
    ds_read_b128 v[36:39], v7 offset:1024
    ds_read_b128 v[40:43], v7 offset:2048
    ds_read_b128 v[44:47], v7 offset:3072
    ds_read_b128 v[48:51], v7 offset:4096
    ds_read_b128 v[52:55], v7 offset:5120
    s_waitcnt lgkmcnt(6)
    v_readfirstlane_b32 s60, v11
    s_cmp_eq_u32 s60, 0
    s_cbranch_scc1 parallel_sum__softmax_full_mha__mixer_channel_mlp__prompt_kernel_fin
    s_cmp_eq_u32 s58, 64
    s_cbranch_scc1 parallel_sum__softmax_full_mha__mixer_channel_mlp__prompt_kernel_fin
    s_mov_b32 s58, 64
    s_waitcnt lgkmcnt(0)
    s_barrier
    s_branch parallel_sum__softmax_full_mha__mixer_channel_mlp__prompt_kernel_restart
parallel_sum__softmax_full_mha__mixer_channel_mlp__prompt_kernel_fin:
    s_waitcnt lgkmcnt(0)
    v_pk_add_f32 v[32:33], v[32:33], v[64:65]
    v_pk_add_f32 v[34:35], v[34:35], v[66:67]
    v_pk_add_f32 v[36:37], v[36:37], v[68:69]
    v_pk_add_f32 v[38:39], v[38:39], v[70:71]
    v_pk_add_f32 v[40:41], v[40:41], v[72:73]
    v_pk_add_f32 v[42:43], v[42:43], v[74:75]
    v_rcp_f32 v4, v40
    s_nop 0
    v_mov_b32 v5, v4
    s_nop 1
    v_permlane32_swap_b32 v4, v5
    s_nop 1
    v_mul_f32 v32, v32, v5
    v_mul_f32 v33, v33, v5
    v_mul_f32 v34, v34, v5
    v_mul_f32 v35, v35, v5
    v_mul_f32 v36, v36, v5
    v_mul_f32 v37, v37, v5
    v_mul_f32 v38, v38, v5
    v_mul_f32 v39, v39, v5
    v_mul_f32 v40, v40, v5
    v_mul_f32 v41, v41, v5
    v_mul_f32 v42, v42, v5
    v_mul_f32 v43, v43, v5
    v_cvt_pk_bf16_f32 v112, v32, v33
    v_cvt_pk_bf16_f32 v113, v34, v35
    v_cvt_pk_bf16_f32 v114, v36, v37
    v_cvt_pk_bf16_f32 v115, v38, v39
    v_cvt_pk_bf16_f32 v116, v40, v41
    v_cvt_pk_bf16_f32 v117, v42, v43
    buffer_store_dwordx4 v[112:115], v17, s[4:7], s64 offen sc1
    s_mov_b64 exec, s[56:57]
    buffer_store_dwordx2 v[116:117], v17, s[4:7], s65 offen sc1
    s_mov_b64 exec, -1
    s_add_u32 s64, s64, 40960
    s_add_u32 s65, s65, 40960
    v_pk_add_f32 v[44:45], v[44:45], v[76:77]
    v_pk_add_f32 v[46:47], v[46:47], v[78:79]
    v_pk_add_f32 v[48:49], v[48:49], v[80:81]
    v_pk_add_f32 v[50:51], v[50:51], v[82:83]
    v_pk_add_f32 v[52:53], v[52:53], v[84:85]
    v_pk_add_f32 v[54:55], v[54:55], v[86:87]
    v_rcp_f32 v4, v52
    s_nop 0
    v_mov_b32 v5, v4
    s_nop 1
    v_permlane32_swap_b32 v4, v5
    s_nop 1
    v_mul_f32 v44, v44, v5
    v_mul_f32 v45, v45, v5
    v_mul_f32 v46, v46, v5
    v_mul_f32 v47, v47, v5
    v_mul_f32 v48, v48, v5
    v_mul_f32 v49, v49, v5
    v_mul_f32 v50, v50, v5
    v_mul_f32 v51, v51, v5
    v_mul_f32 v52, v52, v5
    v_mul_f32 v53, v53, v5
    v_mul_f32 v54, v54, v5
    v_mul_f32 v55, v55, v5
    v_cvt_pk_bf16_f32 v120, v44, v45
    v_cvt_pk_bf16_f32 v121, v46, v47
    v_cvt_pk_bf16_f32 v122, v48, v49
    v_cvt_pk_bf16_f32 v123, v50, v51
    v_cvt_pk_bf16_f32 v124, v52, v53
    v_cvt_pk_bf16_f32 v125, v54, v55
    buffer_store_dwordx4 v[120:123], v17, s[4:7], s64 offen sc1
    s_mov_b64 exec, s[56:57]
    buffer_store_dwordx2 v[124:125], v17, s[4:7], s65 offen sc1
    s_mov_b64 exec, -1
    s_waitcnt vmcnt(0)
    s_mov_b64 exec, 1
    buffer_store_dwordx2 v[14:15], v16, s[4:7], s66 offen sc1
    s_mov_b64 exec, -1
parallel_sum__softmax_full_mha__mixer_channel_mlp__prompt_kernel_done:
    s_endpgm
parallel_sum__softmax_full_mha__mixer_channel_mlp__prompt_kernel_end:
.section .rodata,"a"
.p2align 6
.amdhsa_kernel parallel_sum__softmax_full_mha__mixer_channel_mlp__prompt_kernel
  .amdhsa_next_free_vgpr 256
  .amdhsa_next_free_sgpr 102
  .amdhsa_accum_offset 192
  .amdhsa_group_segment_fixed_size 0
  .amdhsa_kernarg_size 88
  .amdhsa_user_sgpr_count 2
  .amdhsa_user_sgpr_kernarg_segment_ptr 1
  .amdhsa_system_sgpr_workgroup_id_x 1
  .amdhsa_float_denorm_mode_32 3
.end_amdhsa_kernel
```
